```python
import torch

def _softmax(x, axis=-1):
    return torch.softmax(x, dim=axis)
def _gelu(x):
    return torch.nn.functional.gelu(x, approximate="tanh")
def _silu(x):
    return torch.nn.functional.silu(x)
def _sigmoid(x):
    return torch.sigmoid(x)
def _layernorm(x, axis=-1, eps=1e-5):
    m = x.mean(dim=axis, keepdim=True)
    v = x.var(dim=axis, keepdim=True, unbiased=False)
    return (x - m) / torch.sqrt(v + eps)
def _scatter_add(tgt, idx, src, axis=0):
    return tgt.clone().index_add_(axis, idx, src)
def _segment_sum(src, seg, n):
    out = torch.zeros((n,) + src.shape[1:], dtype=src.dtype)
    return out.index_add_(0, seg, src)
def _pad(x, pw):
    flat = tuple(v for pair in reversed(pw) for v in pair)
    return torch.nn.functional.pad(x, flat)

kernel_name = 'sequential_preLN__sliding_local_dilated__mixer_channel_mlp__prompt'

def setup_inputs():

    _w = (lambda a: (lambda t: t.to(torch.bfloat16) if t.is_floating_point() else t)(torch.as_tensor(a)))
    def _A_setup():
        B, S, D = 1, 2048, 512
        return {
            "x": _w((lambda *s: torch.randn(*s, dtype=torch.bfloat16) * 0.05)(B, S, D)),
            "wqkv": _w((lambda *s: torch.randn(*s, dtype=torch.bfloat16) * 0.05)(D, 3 * D)),
            "wo": _w((lambda *s: torch.randn(*s, dtype=torch.bfloat16) * 0.05)(D, D)),
        }
    _A_in = _A_setup()

    def _B_setup():
        B, S, D, F = 1, 2048, 512, 1792
        return {
            "x": _w((lambda *s: torch.randn(*s, dtype=torch.bfloat16) * 0.05)(B, S, D)),
            "w1": _w((lambda *s: torch.randn(*s, dtype=torch.bfloat16) * 3.2)(D, F) * (D ** -0.5)),
            "b1": _w((lambda *s: torch.randn(*s, dtype=torch.bfloat16) * 1.6)(F)),
            "w2": _w((lambda *s: torch.randn(*s, dtype=torch.bfloat16) * 0.2)(F, D) * (F ** -0.5)),
            "b2": _w((lambda *s: torch.randn(*s, dtype=torch.bfloat16) * 0.2)(D)),
        }
    _B_in = _B_setup()

    return {
        "A_x": _A_in["x"],
        "A_wqkv": _A_in["wqkv"],
        "A_wo": _A_in["wo"],
        "B_x": _B_in["x"],
        "B_w1": _B_in["w1"],
        "B_b1": _B_in["b1"],
        "B_w2": _B_in["w2"],
        "B_b2": _B_in["b2"],
    }

def reference(A_x, A_wqkv, A_wo, B_x, B_w1, B_b1, B_w2, B_b2):
    def _A_ref(x, wqkv, wo):
        B, S, D = x.shape
        H = 32; Dh = D // H
        W, dil = 8, 2
        qkv = (lambda x, *d: x.permute(*d))((x @ wqkv).reshape(B, S, 3, H, Dh), 2, 0, 3, 1, 4)
        q, k, v = qkv[0], qkv[1], qkv[2]
        scale = Dh ** -0.5
        pos = torch.arange(S)
        off = torch.arange(W) * dil
        idx = pos[:, None] - off[None, :]
        mask = idx >= 0
        idx_c = torch.where(mask, idx, 0).reshape(-1)
        kg = k[:, :, idx_c, :].reshape(B, H, S, W, Dh)
        vg = v[:, :, idx_c, :].reshape(B, H, S, W, Dh)
        logits = torch.einsum("bhsd,bhswd->bhsw", q, kg) * scale
        logits = torch.where(mask[None, None, :, :], logits, -1e9)
        attn = _softmax(logits, axis=-1)
        o = torch.einsum("bhsw,bhswd->bhsd", attn, vg)
        return (lambda x, *d: x.permute(*d))(o, 0, 2, 1, 3).reshape(B, S, D) @ wo

    def _B_ref(x, w1, b1, w2, b2):
        y = _layernorm(x, axis=-1)
        h = _gelu(torch.einsum("bsd,df->bsf", y, w1) + b1)
        return torch.einsum("bsf,fd->bsd", h, w2) + b2

    x = A_x
    h = x + _A_ref(_layernorm(x, axis=-1), A_wqkv, A_wo)
    h2 = h + _B_ref(_layernorm(h, axis=-1), B_w1, B_b1, B_w2, B_b2)
    return h2
```

```asm
; @launch kernel=sequential_preLN__sliding_local_dilated__mixer_channel_mlp__prompt_k1_kernel grid=(256,1,1) block=(512,1,1) lds=139904
; @launch kernel=sequential_preLN__sliding_local_dilated__mixer_channel_mlp__prompt_k2_kernel grid=(256,1,1) block=(512,1,1) lds=131072
; @launch kernel=sequential_preLN__sliding_local_dilated__mixer_channel_mlp__prompt_k3_kernel grid=(256,1,1) block=(512,1,1) lds=131520
; @launch kernel=sequential_preLN__sliding_local_dilated__mixer_channel_mlp__prompt_k4_kernel grid=(256,1,1) block=(512,1,1) lds=131072
.amdgcn_target "amdgcn-amd-amdhsa--gfx950"
.text
.globl sequential_preLN__sliding_local_dilated__mixer_channel_mlp__prompt_k1_kernel
.p2align 8
.type sequential_preLN__sliding_local_dilated__mixer_channel_mlp__prompt_k1_kernel,@function
sequential_preLN__sliding_local_dilated__mixer_channel_mlp__prompt_k1_kernel:
    s_cmp_ge_u32 s2, 256
    s_nop 0
    s_cbranch_scc1 L_sequential_preLN__sliding_local_dilated__mixer_channel_mlp__prompt_k1_kernel_end
    s_load_dwordx16 s[16:31], s[0:1], 0
    s_load_dwordx2 s[32:33], s[0:1], 64
    s_load_dwordx2 s[34:35], s[0:1], 80
    v_lshrrev_b32 v2, 6, v0
    v_and_b32 v1, 63, v0
    v_readfirstlane_b32 s3, v2
    s_and_b32 s58, s2, 7
    s_lshr_b32 s56, s58, 1
    s_lshl_b32 s56, s56, 3
    s_lshr_b32 s59, s2, 3
    s_and_b32 s60, s59, 7
    s_add_u32 s56, s56, s60
    s_and_b32 s57, s58, 1
    s_lshl_b32 s57, s57, 2
    s_lshr_b32 s59, s59, 3
    s_add_u32 s57, s57, s59
    s_cmp_ge_u32 s3, 4
    s_nop 0
    s_cbranch_scc1 L_sequential_preLN__sliding_local_dilated__mixer_channel_mlp__prompt_k1_kernel_loader
    v_and_b32 v3, 15, v1
    v_lshrrev_b32 v4, 4, v1
    v_and_b32 v12, 7, v1
    v_add_u32 v5, 0, v4
    v_xor_b32 v5, v5, v12
    v_lshlrev_b32 v5, 4, v5
    v_lshl_add_u32 v7, v3, 7, v5
    s_lshl_b32 s58, s3, 11
    v_add_u32 v9, s58, v7
    v_add_u32 v5, 4, v4
    v_xor_b32 v5, v5, v12
    v_lshlrev_b32 v5, 4, v5
    v_lshl_add_u32 v8, v3, 7, v5
    s_lshl_b32 s58, s3, 11
    v_add_u32 v10, s58, v8
    v_lshrrev_b32 v13, 2, v3
    v_and_b32 v14, 3, v3
    v_lshrrev_b32 v5, 1, v14
    s_lshl_b32 s58, s3, 1
    v_add_u32 v5, s58, v5
    v_and_b32 v6, 2, v13
    v_xor_b32 v5, v5, v6
    v_and_b32 v6, 1, v4
    v_lshlrev_b32 v6, 2, v6
    v_xor_b32 v5, v5, v6
    v_lshlrev_b32 v5, 4, v5
    v_and_b32 v6, 1, v14
    v_lshl_add_u32 v5, v6, 3, v5
    v_lshl_add_u32 v6, v4, 3, v13
    v_lshl_add_u32 v5, v6, 7, v5
    v_add_u32 v11, 10240, v5
    v_mov_b32 v20, 1065369472
    v_mov_b32 v21, 1065369472
    v_mov_b32 v22, 1065369472
    v_mov_b32 v23, 1065369472
    v_mov_b32 v32, 0xf149f2ca
    v_lshlrev_b32 v6, 2, v4
    v_sub_u32 v6, v3, v6
    v_add_u32 v5, 16, v6
    v_and_b32 v5, 4294967281, v5
    v_cmp_eq_u32 vcc, 0, v5
    s_nop 1
    v_cndmask_b32 v24, v32, 0, vcc
    v_add_u32 v5, 0, v6
    v_and_b32 v5, 4294967281, v5
    v_cmp_eq_u32 vcc, 0, v5
    s_nop 1
    v_cndmask_b32 v28, v32, 0, vcc
    v_add_u32 v5, 15, v6
    v_and_b32 v5, 4294967281, v5
    v_cmp_eq_u32 vcc, 0, v5
    s_nop 1
    v_cndmask_b32 v25, v32, 0, vcc
    v_add_u32 v5, -1, v6
    v_and_b32 v5, 4294967281, v5
    v_cmp_eq_u32 vcc, 0, v5
    s_nop 1
    v_cndmask_b32 v29, v32, 0, vcc
    v_add_u32 v5, 14, v6
    v_and_b32 v5, 4294967281, v5
    v_cmp_eq_u32 vcc, 0, v5
    s_nop 1
    v_cndmask_b32 v26, v32, 0, vcc
    v_add_u32 v5, -2, v6
    v_and_b32 v5, 4294967281, v5
    v_cmp_eq_u32 vcc, 0, v5
    s_nop 1
    v_cndmask_b32 v30, v32, 0, vcc
    v_add_u32 v5, 13, v6
    v_and_b32 v5, 4294967281, v5
    v_cmp_eq_u32 vcc, 0, v5
    s_nop 1
    v_cndmask_b32 v27, v32, 0, vcc
    v_add_u32 v5, -3, v6
    v_and_b32 v5, 4294967281, v5
    v_cmp_eq_u32 vcc, 0, v5
    s_nop 1
    v_cndmask_b32 v31, v32, 0, vcc
    s_cmp_eq_u32 s56, 0
    s_cselect_b32 s70, 0xf149f2ca, 0
    v_add_f32 v34, s70, v24
    v_add_f32 v35, s70, v25
    v_add_f32 v36, s70, v26
    v_add_f32 v37, s70, v27
    s_mov_b32 s72, 0x3eb8aa3b
    s_mov_b32 s73, 0x3eb8aa3b
    s_lshl_b32 s58, s56, 6
    v_add_u32 v38, s58, v3
    v_lshlrev_b32 v38, 10, v38
    s_lshl_b32 s58, s57, 2
    s_add_u32 s58, s58, s3
    s_lshl_b32 s58, s58, 5
    v_add_u32 v38, s58, v38
    v_lshl_add_u32 v38, v4, 3, v38
    s_lshl_b32 s58, s3, 6
    v_lshl_add_u32 v39, v3, 2, s58
    v_add_u32 v39, 139264, v39
    v_lshlrev_b32 v41, 2, v3
    v_add_u32 v41, 139264, v41
    v_add_u32 v40, 256, v41
    v_lshlrev_b32 v42, 4, v4
    v_add_u32 v42, 139264, v42
    v_and_b32 v5, 3, v1
    v_cmp_eq_u32 s[62:63], 1, v5
    v_cmp_eq_u32 s[64:65], 2, v5
    v_cmp_eq_u32 s[66:67], 3, v5
    v_lshrrev_b32 v5, 2, v3
    v_cmp_eq_u32 s[68:69], v4, v5
    s_waitcnt lgkmcnt(0)
    s_mov_b32 s36, s16
    s_and_b32 s37, s17, 65535
    s_mov_b32 s38, 2097152
    s_mov_b32 s39, 131072
    s_mov_b32 s40, s18
    s_and_b32 s41, s19, 65535
    s_mov_b32 s42, 1572864
    s_mov_b32 s43, 131072
    s_mov_b32 s52, s34
    s_and_b32 s53, s35, 65535
    s_mov_b32 s54, 2097152
    s_mov_b32 s55, 131072
    v_add_u32 v15, 0, v7
    v_add_u32 v17, 0, v9
    v_add_u32 v16, 0, v8
    v_add_u32 v18, 0, v10
    v_add_u32 v19, 0, v11
    s_barrier
    ds_read_b64_tr_b16 v[72:73], v19 offset:8192
    ds_read_b64_tr_b16 v[74:75], v19 offset:8704
    ds_read_b64_tr_b16 v[76:77], v19 offset:16384
    ds_read_b64_tr_b16 v[78:79], v19 offset:16896
    ds_read_b64_tr_b16 v[68:69], v19
    ds_read_b64_tr_b16 v[70:71], v19 offset:512
    ds_read_b128 v[44:47], v15
    ds_read_b128 v[48:51], v15 offset:2048
    ds_read_b128 v[52:55], v15 offset:4096
    ds_read_b128 v[56:59], v15 offset:6144
    ds_read_b128 v[60:63], v15 offset:8192
    ds_read_b128 v[64:67], v17
    s_waitcnt lgkmcnt(0)
    v_mfma_f32_16x16x32_bf16 v[132:135], v[72:75], v[44:47], 0
    ds_read_b64_tr_b16 v[108:109], v19 offset:12288
    ds_read_b64_tr_b16 v[110:111], v19 offset:12800
    v_mfma_f32_16x16x32_bf16 v[152:155], v[44:47], v[76:79], 0
    ds_read_b64_tr_b16 v[112:113], v19 offset:20480
    ds_read_b64_tr_b16 v[114:115], v19 offset:20992
    v_mfma_f32_16x16x32_bf16 v[136:139], v[72:75], v[48:51], 0
    ds_read_b64_tr_b16 v[104:105], v19 offset:4096
    ds_read_b64_tr_b16 v[106:107], v19 offset:4608
    v_mfma_f32_16x16x32_bf16 v[156:159], v[48:51], v[76:79], 0
    ds_read_b128 v[80:83], v16
    ds_read_b128 v[84:87], v16 offset:2048
    v_mfma_f32_16x16x32_bf16 v[116:119], v[68:71], v[48:51], 0
    ds_read_b128 v[88:91], v16 offset:4096
    ds_read_b128 v[92:95], v16 offset:6144
    v_mfma_f32_16x16x32_bf16 v[140:143], v[72:75], v[52:55], 0
    ds_read_b128 v[96:99], v16 offset:8192
    ds_read_b128 v[100:103], v18
    v_mfma_f32_16x16x32_bf16 v[160:163], v[52:55], v[76:79], 0
    v_mfma_f32_16x16x32_bf16 v[120:123], v[68:71], v[52:55], 0
    v_mfma_f32_16x16x32_bf16 v[144:147], v[72:75], v[56:59], 0
    v_mfma_f32_16x16x32_bf16 v[164:167], v[56:59], v[76:79], 0
    v_mfma_f32_16x16x32_bf16 v[124:127], v[68:71], v[56:59], 0
    v_mfma_f32_16x16x32_bf16 v[148:151], v[72:75], v[60:63], 0
    v_mfma_f32_16x16x32_bf16 v[168:171], v[60:63], v[76:79], 0
    v_mfma_f32_16x16x32_bf16 v[128:131], v[68:71], v[60:63], 0
    v_mfma_f32_16x16x32_bf16 v[172:175], v[68:71], v[20:23], 0
    v_mfma_f32_16x16x32_bf16 v[176:179], v[72:75], v[20:23], 0
    v_mfma_f32_16x16x32_bf16 v[180:183], v[20:23], v[76:79], 0
    v_mfma_f32_16x16x32_bf16 v[188:191], v[20:23], v[60:63], 0
    v_mfma_f32_16x16x32_bf16 v[196:199], v[60:63], v[60:63], 0
    v_mfma_f32_16x16x32_bf16 v[184:187], v[20:23], v[64:67], 0
    v_mfma_f32_16x16x32_bf16 v[192:195], v[64:67], v[64:67], 0
    s_waitcnt lgkmcnt(0)
    v_add_u32 v15, 34816, v7
    v_add_u32 v17, 34816, v9
    v_add_u32 v16, 34816, v8
    v_add_u32 v18, 34816, v10
    v_add_u32 v19, 34816, v11
    s_barrier
    v_mfma_f32_16x16x32_bf16 v[132:135], v[108:111], v[80:83], v[132:135]
    ds_read_b64_tr_b16 v[72:73], v19 offset:8192
    ds_read_b64_tr_b16 v[74:75], v19 offset:8704
    v_mfma_f32_16x16x32_bf16 v[152:155], v[80:83], v[112:115], v[152:155]
    ds_read_b64_tr_b16 v[76:77], v19 offset:16384
    ds_read_b64_tr_b16 v[78:79], v19 offset:16896
    v_mfma_f32_16x16x32_bf16 v[136:139], v[108:111], v[84:87], v[136:139]
    ds_read_b64_tr_b16 v[68:69], v19
    ds_read_b64_tr_b16 v[70:71], v19 offset:512
    v_mfma_f32_16x16x32_bf16 v[156:159], v[84:87], v[112:115], v[156:159]
    ds_read_b128 v[44:47], v15
    ds_read_b128 v[48:51], v15 offset:2048
    v_mfma_f32_16x16x32_bf16 v[116:119], v[104:107], v[84:87], v[116:119]
    ds_read_b128 v[52:55], v15 offset:4096
    ds_read_b128 v[56:59], v15 offset:6144
    v_mfma_f32_16x16x32_bf16 v[140:143], v[108:111], v[88:91], v[140:143]
    ds_read_b128 v[60:63], v15 offset:8192
    ds_read_b128 v[64:67], v17
    v_mfma_f32_16x16x32_bf16 v[160:163], v[88:91], v[112:115], v[160:163]
    v_mfma_f32_16x16x32_bf16 v[120:123], v[104:107], v[88:91], v[120:123]
    v_mfma_f32_16x16x32_bf16 v[144:147], v[108:111], v[92:95], v[144:147]
    v_mfma_f32_16x16x32_bf16 v[164:167], v[92:95], v[112:115], v[164:167]
    v_mfma_f32_16x16x32_bf16 v[124:127], v[104:107], v[92:95], v[124:127]
    v_mfma_f32_16x16x32_bf16 v[148:151], v[108:111], v[96:99], v[148:151]
    v_mfma_f32_16x16x32_bf16 v[168:171], v[96:99], v[112:115], v[168:171]
    v_mfma_f32_16x16x32_bf16 v[128:131], v[104:107], v[96:99], v[128:131]
    v_mfma_f32_16x16x32_bf16 v[172:175], v[104:107], v[20:23], v[172:175]
    v_mfma_f32_16x16x32_bf16 v[176:179], v[108:111], v[20:23], v[176:179]
    v_mfma_f32_16x16x32_bf16 v[180:183], v[20:23], v[112:115], v[180:183]
    v_mfma_f32_16x16x32_bf16 v[188:191], v[20:23], v[96:99], v[188:191]
    v_mfma_f32_16x16x32_bf16 v[196:199], v[96:99], v[96:99], v[196:199]
    v_mfma_f32_16x16x32_bf16 v[184:187], v[20:23], v[100:103], v[184:187]
    v_mfma_f32_16x16x32_bf16 v[192:195], v[100:103], v[100:103], v[192:195]
    s_waitcnt lgkmcnt(0)
    v_mfma_f32_16x16x32_bf16 v[132:135], v[72:75], v[44:47], v[132:135]
    ds_read_b64_tr_b16 v[108:109], v19 offset:12288
    ds_read_b64_tr_b16 v[110:111], v19 offset:12800
    v_mfma_f32_16x16x32_bf16 v[152:155], v[44:47], v[76:79], v[152:155]
    ds_read_b64_tr_b16 v[112:113], v19 offset:20480
    ds_read_b64_tr_b16 v[114:115], v19 offset:20992
    v_mfma_f32_16x16x32_bf16 v[136:139], v[72:75], v[48:51], v[136:139]
    ds_read_b64_tr_b16 v[104:105], v19 offset:4096
    ds_read_b64_tr_b16 v[106:107], v19 offset:4608
    v_mfma_f32_16x16x32_bf16 v[156:159], v[48:51], v[76:79], v[156:159]
    ds_read_b128 v[80:83], v16
    ds_read_b128 v[84:87], v16 offset:2048
    v_mfma_f32_16x16x32_bf16 v[116:119], v[68:71], v[48:51], v[116:119]
    ds_read_b128 v[88:91], v16 offset:4096
    ds_read_b128 v[92:95], v16 offset:6144
    v_mfma_f32_16x16x32_bf16 v[140:143], v[72:75], v[52:55], v[140:143]
    ds_read_b128 v[96:99], v16 offset:8192
    ds_read_b128 v[100:103], v18
    v_mfma_f32_16x16x32_bf16 v[160:163], v[52:55], v[76:79], v[160:163]
    v_mfma_f32_16x16x32_bf16 v[120:123], v[68:71], v[52:55], v[120:123]
    v_mfma_f32_16x16x32_bf16 v[144:147], v[72:75], v[56:59], v[144:147]
    v_mfma_f32_16x16x32_bf16 v[164:167], v[56:59], v[76:79], v[164:167]
    v_mfma_f32_16x16x32_bf16 v[124:127], v[68:71], v[56:59], v[124:127]
    v_mfma_f32_16x16x32_bf16 v[148:151], v[72:75], v[60:63], v[148:151]
    v_mfma_f32_16x16x32_bf16 v[168:171], v[60:63], v[76:79], v[168:171]
    v_mfma_f32_16x16x32_bf16 v[128:131], v[68:71], v[60:63], v[128:131]
    v_mfma_f32_16x16x32_bf16 v[172:175], v[68:71], v[20:23], v[172:175]
    v_mfma_f32_16x16x32_bf16 v[176:179], v[72:75], v[20:23], v[176:179]
    v_mfma_f32_16x16x32_bf16 v[180:183], v[20:23], v[76:79], v[180:183]
    v_mfma_f32_16x16x32_bf16 v[188:191], v[20:23], v[60:63], v[188:191]
    v_mfma_f32_16x16x32_bf16 v[196:199], v[60:63], v[60:63], v[196:199]
    v_mfma_f32_16x16x32_bf16 v[184:187], v[20:23], v[64:67], v[184:187]
    v_mfma_f32_16x16x32_bf16 v[192:195], v[64:67], v[64:67], v[192:195]
    s_waitcnt lgkmcnt(0)
    v_add_u32 v15, 69632, v7
    v_add_u32 v17, 69632, v9
    v_add_u32 v16, 69632, v8
    v_add_u32 v18, 69632, v10
    v_add_u32 v19, 69632, v11
    s_barrier
    v_mfma_f32_16x16x32_bf16 v[132:135], v[108:111], v[80:83], v[132:135]
    ds_read_b64_tr_b16 v[72:73], v19 offset:8192
    ds_read_b64_tr_b16 v[74:75], v19 offset:8704
    v_mfma_f32_16x16x32_bf16 v[152:155], v[80:83], v[112:115], v[152:155]
    ds_read_b64_tr_b16 v[76:77], v19 offset:16384
    ds_read_b64_tr_b16 v[78:79], v19 offset:16896
    v_mfma_f32_16x16x32_bf16 v[136:139], v[108:111], v[84:87], v[136:139]
    ds_read_b64_tr_b16 v[68:69], v19
    ds_read_b64_tr_b16 v[70:71], v19 offset:512
    v_mfma_f32_16x16x32_bf16 v[156:159], v[84:87], v[112:115], v[156:159]
    ds_read_b128 v[44:47], v15
    ds_read_b128 v[48:51], v15 offset:2048
    v_mfma_f32_16x16x32_bf16 v[116:119], v[104:107], v[84:87], v[116:119]
    ds_read_b128 v[52:55], v15 offset:4096
    ds_read_b128 v[56:59], v15 offset:6144
    v_mfma_f32_16x16x32_bf16 v[140:143], v[108:111], v[88:91], v[140:143]
    ds_read_b128 v[60:63], v15 offset:8192
    ds_read_b128 v[64:67], v17
    v_mfma_f32_16x16x32_bf16 v[160:163], v[88:91], v[112:115], v[160:163]
    v_mfma_f32_16x16x32_bf16 v[120:123], v[104:107], v[88:91], v[120:123]
    v_mfma_f32_16x16x32_bf16 v[144:147], v[108:111], v[92:95], v[144:147]
    v_mfma_f32_16x16x32_bf16 v[164:167], v[92:95], v[112:115], v[164:167]
    v_mfma_f32_16x16x32_bf16 v[124:127], v[104:107], v[92:95], v[124:127]
    v_mfma_f32_16x16x32_bf16 v[148:151], v[108:111], v[96:99], v[148:151]
    v_mfma_f32_16x16x32_bf16 v[168:171], v[96:99], v[112:115], v[168:171]
    v_mfma_f32_16x16x32_bf16 v[128:131], v[104:107], v[96:99], v[128:131]
    v_mfma_f32_16x16x32_bf16 v[172:175], v[104:107], v[20:23], v[172:175]
    v_mfma_f32_16x16x32_bf16 v[176:179], v[108:111], v[20:23], v[176:179]
    v_mfma_f32_16x16x32_bf16 v[180:183], v[20:23], v[112:115], v[180:183]
    v_mfma_f32_16x16x32_bf16 v[188:191], v[20:23], v[96:99], v[188:191]
    v_mfma_f32_16x16x32_bf16 v[196:199], v[96:99], v[96:99], v[196:199]
    v_mfma_f32_16x16x32_bf16 v[184:187], v[20:23], v[100:103], v[184:187]
    v_mfma_f32_16x16x32_bf16 v[192:195], v[100:103], v[100:103], v[192:195]
    s_waitcnt lgkmcnt(0)
    v_mfma_f32_16x16x32_bf16 v[132:135], v[72:75], v[44:47], v[132:135]
    ds_read_b64_tr_b16 v[108:109], v19 offset:12288
    ds_read_b64_tr_b16 v[110:111], v19 offset:12800
    v_mfma_f32_16x16x32_bf16 v[152:155], v[44:47], v[76:79], v[152:155]
    ds_read_b64_tr_b16 v[112:113], v19 offset:20480
    ds_read_b64_tr_b16 v[114:115], v19 offset:20992
    v_mfma_f32_16x16x32_bf16 v[136:139], v[72:75], v[48:51], v[136:139]
    ds_read_b64_tr_b16 v[104:105], v19 offset:4096
    ds_read_b64_tr_b16 v[106:107], v19 offset:4608
    v_mfma_f32_16x16x32_bf16 v[156:159], v[48:51], v[76:79], v[156:159]
    ds_read_b128 v[80:83], v16
    ds_read_b128 v[84:87], v16 offset:2048
    v_mfma_f32_16x16x32_bf16 v[116:119], v[68:71], v[48:51], v[116:119]
    ds_read_b128 v[88:91], v16 offset:4096
    ds_read_b128 v[92:95], v16 offset:6144
    v_mfma_f32_16x16x32_bf16 v[140:143], v[72:75], v[52:55], v[140:143]
    ds_read_b128 v[96:99], v16 offset:8192
    ds_read_b128 v[100:103], v18
    v_mfma_f32_16x16x32_bf16 v[160:163], v[52:55], v[76:79], v[160:163]
    v_mfma_f32_16x16x32_bf16 v[120:123], v[68:71], v[52:55], v[120:123]
    v_mfma_f32_16x16x32_bf16 v[144:147], v[72:75], v[56:59], v[144:147]
    v_mfma_f32_16x16x32_bf16 v[164:167], v[56:59], v[76:79], v[164:167]
    v_mfma_f32_16x16x32_bf16 v[124:127], v[68:71], v[56:59], v[124:127]
    v_mfma_f32_16x16x32_bf16 v[148:151], v[72:75], v[60:63], v[148:151]
    v_mfma_f32_16x16x32_bf16 v[168:171], v[60:63], v[76:79], v[168:171]
    v_mfma_f32_16x16x32_bf16 v[128:131], v[68:71], v[60:63], v[128:131]
    v_mfma_f32_16x16x32_bf16 v[172:175], v[68:71], v[20:23], v[172:175]
    v_mfma_f32_16x16x32_bf16 v[176:179], v[72:75], v[20:23], v[176:179]
    v_mfma_f32_16x16x32_bf16 v[180:183], v[20:23], v[76:79], v[180:183]
    v_mfma_f32_16x16x32_bf16 v[188:191], v[20:23], v[60:63], v[188:191]
    v_mfma_f32_16x16x32_bf16 v[196:199], v[60:63], v[60:63], v[196:199]
    v_mfma_f32_16x16x32_bf16 v[184:187], v[20:23], v[64:67], v[184:187]
    v_mfma_f32_16x16x32_bf16 v[192:195], v[64:67], v[64:67], v[192:195]
    s_waitcnt lgkmcnt(0)
    v_add_u32 v15, 104448, v7
    v_add_u32 v17, 104448, v9
    v_add_u32 v16, 104448, v8
    v_add_u32 v18, 104448, v10
    v_add_u32 v19, 104448, v11
    s_barrier
    v_mfma_f32_16x16x32_bf16 v[132:135], v[108:111], v[80:83], v[132:135]
    ds_read_b64_tr_b16 v[72:73], v19 offset:8192
    ds_read_b64_tr_b16 v[74:75], v19 offset:8704
    v_mfma_f32_16x16x32_bf16 v[152:155], v[80:83], v[112:115], v[152:155]
    ds_read_b64_tr_b16 v[76:77], v19 offset:16384
    ds_read_b64_tr_b16 v[78:79], v19 offset:16896
    v_mfma_f32_16x16x32_bf16 v[136:139], v[108:111], v[84:87], v[136:139]
    ds_read_b64_tr_b16 v[68:69], v19
    ds_read_b64_tr_b16 v[70:71], v19 offset:512
    v_mfma_f32_16x16x32_bf16 v[156:159], v[84:87], v[112:115], v[156:159]
    ds_read_b128 v[44:47], v15
    ds_read_b128 v[48:51], v15 offset:2048
    v_mfma_f32_16x16x32_bf16 v[116:119], v[104:107], v[84:87], v[116:119]
    ds_read_b128 v[52:55], v15 offset:4096
    ds_read_b128 v[56:59], v15 offset:6144
    v_mfma_f32_16x16x32_bf16 v[140:143], v[108:111], v[88:91], v[140:143]
    ds_read_b128 v[60:63], v15 offset:8192
    ds_read_b128 v[64:67], v17
    v_mfma_f32_16x16x32_bf16 v[160:163], v[88:91], v[112:115], v[160:163]
    v_mfma_f32_16x16x32_bf16 v[120:123], v[104:107], v[88:91], v[120:123]
    v_mfma_f32_16x16x32_bf16 v[144:147], v[108:111], v[92:95], v[144:147]
    v_mfma_f32_16x16x32_bf16 v[164:167], v[92:95], v[112:115], v[164:167]
    v_mfma_f32_16x16x32_bf16 v[124:127], v[104:107], v[92:95], v[124:127]
    v_mfma_f32_16x16x32_bf16 v[148:151], v[108:111], v[96:99], v[148:151]
    v_mfma_f32_16x16x32_bf16 v[168:171], v[96:99], v[112:115], v[168:171]
    v_mfma_f32_16x16x32_bf16 v[128:131], v[104:107], v[96:99], v[128:131]
    v_mfma_f32_16x16x32_bf16 v[172:175], v[104:107], v[20:23], v[172:175]
    v_mfma_f32_16x16x32_bf16 v[176:179], v[108:111], v[20:23], v[176:179]
    v_mfma_f32_16x16x32_bf16 v[180:183], v[20:23], v[112:115], v[180:183]
    v_mfma_f32_16x16x32_bf16 v[188:191], v[20:23], v[96:99], v[188:191]
    v_mfma_f32_16x16x32_bf16 v[196:199], v[96:99], v[96:99], v[196:199]
    v_mfma_f32_16x16x32_bf16 v[184:187], v[20:23], v[100:103], v[184:187]
    v_mfma_f32_16x16x32_bf16 v[192:195], v[100:103], v[100:103], v[192:195]
    s_waitcnt lgkmcnt(0)
    v_mfma_f32_16x16x32_bf16 v[132:135], v[72:75], v[44:47], v[132:135]
    ds_read_b64_tr_b16 v[108:109], v19 offset:12288
    ds_read_b64_tr_b16 v[110:111], v19 offset:12800
    v_mfma_f32_16x16x32_bf16 v[152:155], v[44:47], v[76:79], v[152:155]
    ds_read_b64_tr_b16 v[112:113], v19 offset:20480
    ds_read_b64_tr_b16 v[114:115], v19 offset:20992
    v_mfma_f32_16x16x32_bf16 v[136:139], v[72:75], v[48:51], v[136:139]
    ds_read_b64_tr_b16 v[104:105], v19 offset:4096
    ds_read_b64_tr_b16 v[106:107], v19 offset:4608
    v_mfma_f32_16x16x32_bf16 v[156:159], v[48:51], v[76:79], v[156:159]
    ds_read_b128 v[80:83], v16
    ds_read_b128 v[84:87], v16 offset:2048
    v_mfma_f32_16x16x32_bf16 v[116:119], v[68:71], v[48:51], v[116:119]
    ds_read_b128 v[88:91], v16 offset:4096
    ds_read_b128 v[92:95], v16 offset:6144
    v_mfma_f32_16x16x32_bf16 v[140:143], v[72:75], v[52:55], v[140:143]
    ds_read_b128 v[96:99], v16 offset:8192
    ds_read_b128 v[100:103], v18
    v_mfma_f32_16x16x32_bf16 v[160:163], v[52:55], v[76:79], v[160:163]
    v_mfma_f32_16x16x32_bf16 v[120:123], v[68:71], v[52:55], v[120:123]
    v_mfma_f32_16x16x32_bf16 v[144:147], v[72:75], v[56:59], v[144:147]
    v_mfma_f32_16x16x32_bf16 v[164:167], v[56:59], v[76:79], v[164:167]
    v_mfma_f32_16x16x32_bf16 v[124:127], v[68:71], v[56:59], v[124:127]
    v_mfma_f32_16x16x32_bf16 v[148:151], v[72:75], v[60:63], v[148:151]
    v_mfma_f32_16x16x32_bf16 v[168:171], v[60:63], v[76:79], v[168:171]
    v_mfma_f32_16x16x32_bf16 v[128:131], v[68:71], v[60:63], v[128:131]
    v_mfma_f32_16x16x32_bf16 v[172:175], v[68:71], v[20:23], v[172:175]
    v_mfma_f32_16x16x32_bf16 v[176:179], v[72:75], v[20:23], v[176:179]
    v_mfma_f32_16x16x32_bf16 v[180:183], v[20:23], v[76:79], v[180:183]
    v_mfma_f32_16x16x32_bf16 v[188:191], v[20:23], v[60:63], v[188:191]
    v_mfma_f32_16x16x32_bf16 v[196:199], v[60:63], v[60:63], v[196:199]
    v_mfma_f32_16x16x32_bf16 v[184:187], v[20:23], v[64:67], v[184:187]
    v_mfma_f32_16x16x32_bf16 v[192:195], v[64:67], v[64:67], v[192:195]
    s_waitcnt lgkmcnt(0)
    v_add_u32 v15, 0, v7
    v_add_u32 v17, 0, v9
    v_add_u32 v16, 0, v8
    v_add_u32 v18, 0, v10
    v_add_u32 v19, 0, v11
    s_barrier
    v_mfma_f32_16x16x32_bf16 v[132:135], v[108:111], v[80:83], v[132:135]
    ds_read_b64_tr_b16 v[72:73], v19 offset:8192
    ds_read_b64_tr_b16 v[74:75], v19 offset:8704
    v_mfma_f32_16x16x32_bf16 v[152:155], v[80:83], v[112:115], v[152:155]
    ds_read_b64_tr_b16 v[76:77], v19 offset:16384
    ds_read_b64_tr_b16 v[78:79], v19 offset:16896
    v_mfma_f32_16x16x32_bf16 v[136:139], v[108:111], v[84:87], v[136:139]
    ds_read_b64_tr_b16 v[68:69], v19
    ds_read_b64_tr_b16 v[70:71], v19 offset:512
    v_mfma_f32_16x16x32_bf16 v[156:159], v[84:87], v[112:115], v[156:159]
    ds_read_b128 v[44:47], v15
    ds_read_b128 v[48:51], v15 offset:2048
    v_mfma_f32_16x16x32_bf16 v[116:119], v[104:107], v[84:87], v[116:119]
    ds_read_b128 v[52:55], v15 offset:4096
    ds_read_b128 v[56:59], v15 offset:6144
    v_mfma_f32_16x16x32_bf16 v[140:143], v[108:111], v[88:91], v[140:143]
    ds_read_b128 v[60:63], v15 offset:8192
    ds_read_b128 v[64:67], v17
    v_mfma_f32_16x16x32_bf16 v[160:163], v[88:91], v[112:115], v[160:163]
    v_mfma_f32_16x16x32_bf16 v[120:123], v[104:107], v[88:91], v[120:123]
    v_mfma_f32_16x16x32_bf16 v[144:147], v[108:111], v[92:95], v[144:147]
    v_mfma_f32_16x16x32_bf16 v[164:167], v[92:95], v[112:115], v[164:167]
    v_mfma_f32_16x16x32_bf16 v[124:127], v[104:107], v[92:95], v[124:127]
    v_mfma_f32_16x16x32_bf16 v[148:151], v[108:111], v[96:99], v[148:151]
    v_mfma_f32_16x16x32_bf16 v[168:171], v[96:99], v[112:115], v[168:171]
    v_mfma_f32_16x16x32_bf16 v[128:131], v[104:107], v[96:99], v[128:131]
    v_mfma_f32_16x16x32_bf16 v[172:175], v[104:107], v[20:23], v[172:175]
    v_mfma_f32_16x16x32_bf16 v[176:179], v[108:111], v[20:23], v[176:179]
    v_mfma_f32_16x16x32_bf16 v[180:183], v[20:23], v[112:115], v[180:183]
    v_mfma_f32_16x16x32_bf16 v[188:191], v[20:23], v[96:99], v[188:191]
    v_mfma_f32_16x16x32_bf16 v[196:199], v[96:99], v[96:99], v[196:199]
    v_mfma_f32_16x16x32_bf16 v[184:187], v[20:23], v[100:103], v[184:187]
    v_mfma_f32_16x16x32_bf16 v[192:195], v[100:103], v[100:103], v[192:195]
    s_waitcnt lgkmcnt(0)
    v_mfma_f32_16x16x32_bf16 v[132:135], v[72:75], v[44:47], v[132:135]
    ds_read_b64_tr_b16 v[108:109], v19 offset:12288
    ds_read_b64_tr_b16 v[110:111], v19 offset:12800
    v_mfma_f32_16x16x32_bf16 v[152:155], v[44:47], v[76:79], v[152:155]
    ds_read_b64_tr_b16 v[112:113], v19 offset:20480
    ds_read_b64_tr_b16 v[114:115], v19 offset:20992
    v_mfma_f32_16x16x32_bf16 v[136:139], v[72:75], v[48:51], v[136:139]
    ds_read_b64_tr_b16 v[104:105], v19 offset:4096
    ds_read_b64_tr_b16 v[106:107], v19 offset:4608
    v_mfma_f32_16x16x32_bf16 v[156:159], v[48:51], v[76:79], v[156:159]
    ds_read_b128 v[80:83], v16
    ds_read_b128 v[84:87], v16 offset:2048
    v_mfma_f32_16x16x32_bf16 v[116:119], v[68:71], v[48:51], v[116:119]
    ds_read_b128 v[88:91], v16 offset:4096
    ds_read_b128 v[92:95], v16 offset:6144
    v_mfma_f32_16x16x32_bf16 v[140:143], v[72:75], v[52:55], v[140:143]
    ds_read_b128 v[96:99], v16 offset:8192
    ds_read_b128 v[100:103], v18
    v_mfma_f32_16x16x32_bf16 v[160:163], v[52:55], v[76:79], v[160:163]
    v_mfma_f32_16x16x32_bf16 v[120:123], v[68:71], v[52:55], v[120:123]
    v_mfma_f32_16x16x32_bf16 v[144:147], v[72:75], v[56:59], v[144:147]
    v_mfma_f32_16x16x32_bf16 v[164:167], v[56:59], v[76:79], v[164:167]
    v_mfma_f32_16x16x32_bf16 v[124:127], v[68:71], v[56:59], v[124:127]
    v_mfma_f32_16x16x32_bf16 v[148:151], v[72:75], v[60:63], v[148:151]
    v_mfma_f32_16x16x32_bf16 v[168:171], v[60:63], v[76:79], v[168:171]
    v_mfma_f32_16x16x32_bf16 v[128:131], v[68:71], v[60:63], v[128:131]
    v_mfma_f32_16x16x32_bf16 v[172:175], v[68:71], v[20:23], v[172:175]
    v_mfma_f32_16x16x32_bf16 v[176:179], v[72:75], v[20:23], v[176:179]
    v_mfma_f32_16x16x32_bf16 v[180:183], v[20:23], v[76:79], v[180:183]
    v_mfma_f32_16x16x32_bf16 v[188:191], v[20:23], v[60:63], v[188:191]
    v_mfma_f32_16x16x32_bf16 v[196:199], v[60:63], v[60:63], v[196:199]
    v_mfma_f32_16x16x32_bf16 v[184:187], v[20:23], v[64:67], v[184:187]
    v_mfma_f32_16x16x32_bf16 v[192:195], v[64:67], v[64:67], v[192:195]
    s_waitcnt lgkmcnt(0)
    v_add_u32 v15, 34816, v7
    v_add_u32 v17, 34816, v9
    v_add_u32 v16, 34816, v8
    v_add_u32 v18, 34816, v10
    v_add_u32 v19, 34816, v11
    s_barrier
    v_mfma_f32_16x16x32_bf16 v[132:135], v[108:111], v[80:83], v[132:135]
    ds_read_b64_tr_b16 v[72:73], v19 offset:8192
    ds_read_b64_tr_b16 v[74:75], v19 offset:8704
    v_mfma_f32_16x16x32_bf16 v[152:155], v[80:83], v[112:115], v[152:155]
    ds_read_b64_tr_b16 v[76:77], v19 offset:16384
    ds_read_b64_tr_b16 v[78:79], v19 offset:16896
    v_mfma_f32_16x16x32_bf16 v[136:139], v[108:111], v[84:87], v[136:139]
    ds_read_b64_tr_b16 v[68:69], v19
    ds_read_b64_tr_b16 v[70:71], v19 offset:512
    v_mfma_f32_16x16x32_bf16 v[156:159], v[84:87], v[112:115], v[156:159]
    ds_read_b128 v[44:47], v15
    ds_read_b128 v[48:51], v15 offset:2048
    v_mfma_f32_16x16x32_bf16 v[116:119], v[104:107], v[84:87], v[116:119]
    ds_read_b128 v[52:55], v15 offset:4096
    ds_read_b128 v[56:59], v15 offset:6144
    v_mfma_f32_16x16x32_bf16 v[140:143], v[108:111], v[88:91], v[140:143]
    ds_read_b128 v[60:63], v15 offset:8192
    ds_read_b128 v[64:67], v17
    v_mfma_f32_16x16x32_bf16 v[160:163], v[88:91], v[112:115], v[160:163]
    v_mfma_f32_16x16x32_bf16 v[120:123], v[104:107], v[88:91], v[120:123]
    v_mfma_f32_16x16x32_bf16 v[144:147], v[108:111], v[92:95], v[144:147]
    v_mfma_f32_16x16x32_bf16 v[164:167], v[92:95], v[112:115], v[164:167]
    v_mfma_f32_16x16x32_bf16 v[124:127], v[104:107], v[92:95], v[124:127]
    v_mfma_f32_16x16x32_bf16 v[148:151], v[108:111], v[96:99], v[148:151]
    v_mfma_f32_16x16x32_bf16 v[168:171], v[96:99], v[112:115], v[168:171]
    v_mfma_f32_16x16x32_bf16 v[128:131], v[104:107], v[96:99], v[128:131]
    v_mfma_f32_16x16x32_bf16 v[172:175], v[104:107], v[20:23], v[172:175]
    v_mfma_f32_16x16x32_bf16 v[176:179], v[108:111], v[20:23], v[176:179]
    v_mfma_f32_16x16x32_bf16 v[180:183], v[20:23], v[112:115], v[180:183]
    v_mfma_f32_16x16x32_bf16 v[188:191], v[20:23], v[96:99], v[188:191]
    v_mfma_f32_16x16x32_bf16 v[196:199], v[96:99], v[96:99], v[196:199]
    v_mfma_f32_16x16x32_bf16 v[184:187], v[20:23], v[100:103], v[184:187]
    v_mfma_f32_16x16x32_bf16 v[192:195], v[100:103], v[100:103], v[192:195]
    s_waitcnt lgkmcnt(0)
    v_mfma_f32_16x16x32_bf16 v[132:135], v[72:75], v[44:47], v[132:135]
    ds_read_b64_tr_b16 v[108:109], v19 offset:12288
    ds_read_b64_tr_b16 v[110:111], v19 offset:12800
    v_mfma_f32_16x16x32_bf16 v[152:155], v[44:47], v[76:79], v[152:155]
    ds_read_b64_tr_b16 v[112:113], v19 offset:20480
    ds_read_b64_tr_b16 v[114:115], v19 offset:20992
    v_mfma_f32_16x16x32_bf16 v[136:139], v[72:75], v[48:51], v[136:139]
    ds_read_b64_tr_b16 v[104:105], v19 offset:4096
    ds_read_b64_tr_b16 v[106:107], v19 offset:4608
    v_mfma_f32_16x16x32_bf16 v[156:159], v[48:51], v[76:79], v[156:159]
    ds_read_b128 v[80:83], v16
    ds_read_b128 v[84:87], v16 offset:2048
    v_mfma_f32_16x16x32_bf16 v[116:119], v[68:71], v[48:51], v[116:119]
    ds_read_b128 v[88:91], v16 offset:4096
    ds_read_b128 v[92:95], v16 offset:6144
    v_mfma_f32_16x16x32_bf16 v[140:143], v[72:75], v[52:55], v[140:143]
    ds_read_b128 v[96:99], v16 offset:8192
    ds_read_b128 v[100:103], v18
    v_mfma_f32_16x16x32_bf16 v[160:163], v[52:55], v[76:79], v[160:163]
    v_mfma_f32_16x16x32_bf16 v[120:123], v[68:71], v[52:55], v[120:123]
    v_mfma_f32_16x16x32_bf16 v[144:147], v[72:75], v[56:59], v[144:147]
    v_mfma_f32_16x16x32_bf16 v[164:167], v[56:59], v[76:79], v[164:167]
    v_mfma_f32_16x16x32_bf16 v[124:127], v[68:71], v[56:59], v[124:127]
    v_mfma_f32_16x16x32_bf16 v[148:151], v[72:75], v[60:63], v[148:151]
    v_mfma_f32_16x16x32_bf16 v[168:171], v[60:63], v[76:79], v[168:171]
    v_mfma_f32_16x16x32_bf16 v[128:131], v[68:71], v[60:63], v[128:131]
    v_mfma_f32_16x16x32_bf16 v[172:175], v[68:71], v[20:23], v[172:175]
    v_mfma_f32_16x16x32_bf16 v[176:179], v[72:75], v[20:23], v[176:179]
    v_mfma_f32_16x16x32_bf16 v[180:183], v[20:23], v[76:79], v[180:183]
    v_mfma_f32_16x16x32_bf16 v[188:191], v[20:23], v[60:63], v[188:191]
    v_mfma_f32_16x16x32_bf16 v[196:199], v[60:63], v[60:63], v[196:199]
    v_mfma_f32_16x16x32_bf16 v[184:187], v[20:23], v[64:67], v[184:187]
    v_mfma_f32_16x16x32_bf16 v[192:195], v[64:67], v[64:67], v[192:195]
    s_waitcnt lgkmcnt(0)
    v_add_u32 v15, 69632, v7
    v_add_u32 v17, 69632, v9
    v_add_u32 v16, 69632, v8
    v_add_u32 v18, 69632, v10
    v_add_u32 v19, 69632, v11
    s_barrier
    v_mfma_f32_16x16x32_bf16 v[132:135], v[108:111], v[80:83], v[132:135]
    ds_read_b64_tr_b16 v[72:73], v19 offset:8192
    ds_read_b64_tr_b16 v[74:75], v19 offset:8704
    v_mfma_f32_16x16x32_bf16 v[152:155], v[80:83], v[112:115], v[152:155]
    ds_read_b64_tr_b16 v[76:77], v19 offset:16384
    ds_read_b64_tr_b16 v[78:79], v19 offset:16896
    v_mfma_f32_16x16x32_bf16 v[136:139], v[108:111], v[84:87], v[136:139]
    ds_read_b64_tr_b16 v[68:69], v19
    ds_read_b64_tr_b16 v[70:71], v19 offset:512
    v_mfma_f32_16x16x32_bf16 v[156:159], v[84:87], v[112:115], v[156:159]
    ds_read_b128 v[44:47], v15
    ds_read_b128 v[48:51], v15 offset:2048
    v_mfma_f32_16x16x32_bf16 v[116:119], v[104:107], v[84:87], v[116:119]
    ds_read_b128 v[52:55], v15 offset:4096
    ds_read_b128 v[56:59], v15 offset:6144
    v_mfma_f32_16x16x32_bf16 v[140:143], v[108:111], v[88:91], v[140:143]
    ds_read_b128 v[60:63], v15 offset:8192
    ds_read_b128 v[64:67], v17
    v_mfma_f32_16x16x32_bf16 v[160:163], v[88:91], v[112:115], v[160:163]
    v_mfma_f32_16x16x32_bf16 v[120:123], v[104:107], v[88:91], v[120:123]
    v_mfma_f32_16x16x32_bf16 v[144:147], v[108:111], v[92:95], v[144:147]
    v_mfma_f32_16x16x32_bf16 v[164:167], v[92:95], v[112:115], v[164:167]
    v_mfma_f32_16x16x32_bf16 v[124:127], v[104:107], v[92:95], v[124:127]
    v_mfma_f32_16x16x32_bf16 v[148:151], v[108:111], v[96:99], v[148:151]
    v_mfma_f32_16x16x32_bf16 v[168:171], v[96:99], v[112:115], v[168:171]
    v_mfma_f32_16x16x32_bf16 v[128:131], v[104:107], v[96:99], v[128:131]
    v_mfma_f32_16x16x32_bf16 v[172:175], v[104:107], v[20:23], v[172:175]
    v_mfma_f32_16x16x32_bf16 v[176:179], v[108:111], v[20:23], v[176:179]
    v_mfma_f32_16x16x32_bf16 v[180:183], v[20:23], v[112:115], v[180:183]
    v_mfma_f32_16x16x32_bf16 v[188:191], v[20:23], v[96:99], v[188:191]
    v_mfma_f32_16x16x32_bf16 v[196:199], v[96:99], v[96:99], v[196:199]
    v_mfma_f32_16x16x32_bf16 v[184:187], v[20:23], v[100:103], v[184:187]
    v_mfma_f32_16x16x32_bf16 v[192:195], v[100:103], v[100:103], v[192:195]
    s_waitcnt lgkmcnt(0)
    v_mfma_f32_16x16x32_bf16 v[132:135], v[72:75], v[44:47], v[132:135]
    ds_read_b64_tr_b16 v[108:109], v19 offset:12288
    ds_read_b64_tr_b16 v[110:111], v19 offset:12800
    v_mfma_f32_16x16x32_bf16 v[152:155], v[44:47], v[76:79], v[152:155]
    ds_read_b64_tr_b16 v[112:113], v19 offset:20480
    ds_read_b64_tr_b16 v[114:115], v19 offset:20992
    v_mfma_f32_16x16x32_bf16 v[136:139], v[72:75], v[48:51], v[136:139]
    ds_read_b64_tr_b16 v[104:105], v19 offset:4096
    ds_read_b64_tr_b16 v[106:107], v19 offset:4608
    v_mfma_f32_16x16x32_bf16 v[156:159], v[48:51], v[76:79], v[156:159]
    ds_read_b128 v[80:83], v16
    ds_read_b128 v[84:87], v16 offset:2048
    v_mfma_f32_16x16x32_bf16 v[116:119], v[68:71], v[48:51], v[116:119]
    ds_read_b128 v[88:91], v16 offset:4096
    ds_read_b128 v[92:95], v16 offset:6144
    v_mfma_f32_16x16x32_bf16 v[140:143], v[72:75], v[52:55], v[140:143]
    ds_read_b128 v[96:99], v16 offset:8192
    ds_read_b128 v[100:103], v18
    v_mfma_f32_16x16x32_bf16 v[160:163], v[52:55], v[76:79], v[160:163]
    v_mfma_f32_16x16x32_bf16 v[120:123], v[68:71], v[52:55], v[120:123]
    v_mfma_f32_16x16x32_bf16 v[144:147], v[72:75], v[56:59], v[144:147]
    v_mfma_f32_16x16x32_bf16 v[164:167], v[56:59], v[76:79], v[164:167]
    v_mfma_f32_16x16x32_bf16 v[124:127], v[68:71], v[56:59], v[124:127]
    v_mfma_f32_16x16x32_bf16 v[148:151], v[72:75], v[60:63], v[148:151]
    v_mfma_f32_16x16x32_bf16 v[168:171], v[60:63], v[76:79], v[168:171]
    v_mfma_f32_16x16x32_bf16 v[128:131], v[68:71], v[60:63], v[128:131]
    v_mfma_f32_16x16x32_bf16 v[172:175], v[68:71], v[20:23], v[172:175]
    v_mfma_f32_16x16x32_bf16 v[176:179], v[72:75], v[20:23], v[176:179]
    v_mfma_f32_16x16x32_bf16 v[180:183], v[20:23], v[76:79], v[180:183]
    v_mfma_f32_16x16x32_bf16 v[188:191], v[20:23], v[60:63], v[188:191]
    v_mfma_f32_16x16x32_bf16 v[196:199], v[60:63], v[60:63], v[196:199]
    v_mfma_f32_16x16x32_bf16 v[184:187], v[20:23], v[64:67], v[184:187]
    v_mfma_f32_16x16x32_bf16 v[192:195], v[64:67], v[64:67], v[192:195]
    s_waitcnt lgkmcnt(0)
    v_add_u32 v15, 104448, v7
    v_add_u32 v17, 104448, v9
    v_add_u32 v16, 104448, v8
    v_add_u32 v18, 104448, v10
    v_add_u32 v19, 104448, v11
    s_barrier
    v_mfma_f32_16x16x32_bf16 v[132:135], v[108:111], v[80:83], v[132:135]
    ds_read_b64_tr_b16 v[72:73], v19 offset:8192
    ds_read_b64_tr_b16 v[74:75], v19 offset:8704
    v_mfma_f32_16x16x32_bf16 v[152:155], v[80:83], v[112:115], v[152:155]
    ds_read_b64_tr_b16 v[76:77], v19 offset:16384
    ds_read_b64_tr_b16 v[78:79], v19 offset:16896
    v_mfma_f32_16x16x32_bf16 v[136:139], v[108:111], v[84:87], v[136:139]
    ds_read_b64_tr_b16 v[68:69], v19
    ds_read_b64_tr_b16 v[70:71], v19 offset:512
    v_mfma_f32_16x16x32_bf16 v[156:159], v[84:87], v[112:115], v[156:159]
    ds_read_b128 v[44:47], v15
    ds_read_b128 v[48:51], v15 offset:2048
    v_mfma_f32_16x16x32_bf16 v[116:119], v[104:107], v[84:87], v[116:119]
    ds_read_b128 v[52:55], v15 offset:4096
    ds_read_b128 v[56:59], v15 offset:6144
    v_mfma_f32_16x16x32_bf16 v[140:143], v[108:111], v[88:91], v[140:143]
    ds_read_b128 v[60:63], v15 offset:8192
    ds_read_b128 v[64:67], v17
    v_mfma_f32_16x16x32_bf16 v[160:163], v[88:91], v[112:115], v[160:163]
    v_mfma_f32_16x16x32_bf16 v[120:123], v[104:107], v[88:91], v[120:123]
    v_mfma_f32_16x16x32_bf16 v[144:147], v[108:111], v[92:95], v[144:147]
    v_mfma_f32_16x16x32_bf16 v[164:167], v[92:95], v[112:115], v[164:167]
    v_mfma_f32_16x16x32_bf16 v[124:127], v[104:107], v[92:95], v[124:127]
    v_mfma_f32_16x16x32_bf16 v[148:151], v[108:111], v[96:99], v[148:151]
    v_mfma_f32_16x16x32_bf16 v[168:171], v[96:99], v[112:115], v[168:171]
    v_mfma_f32_16x16x32_bf16 v[128:131], v[104:107], v[96:99], v[128:131]
    v_mfma_f32_16x16x32_bf16 v[172:175], v[104:107], v[20:23], v[172:175]
    v_mfma_f32_16x16x32_bf16 v[176:179], v[108:111], v[20:23], v[176:179]
    v_mfma_f32_16x16x32_bf16 v[180:183], v[20:23], v[112:115], v[180:183]
    v_mfma_f32_16x16x32_bf16 v[188:191], v[20:23], v[96:99], v[188:191]
    v_mfma_f32_16x16x32_bf16 v[196:199], v[96:99], v[96:99], v[196:199]
    v_mfma_f32_16x16x32_bf16 v[184:187], v[20:23], v[100:103], v[184:187]
    v_mfma_f32_16x16x32_bf16 v[192:195], v[100:103], v[100:103], v[192:195]
    s_waitcnt lgkmcnt(0)
    v_mfma_f32_16x16x32_bf16 v[132:135], v[72:75], v[44:47], v[132:135]
    ds_read_b64_tr_b16 v[108:109], v19 offset:12288
    ds_read_b64_tr_b16 v[110:111], v19 offset:12800
    v_mfma_f32_16x16x32_bf16 v[152:155], v[44:47], v[76:79], v[152:155]
    ds_read_b64_tr_b16 v[112:113], v19 offset:20480
    ds_read_b64_tr_b16 v[114:115], v19 offset:20992
    v_mfma_f32_16x16x32_bf16 v[136:139], v[72:75], v[48:51], v[136:139]
    ds_read_b64_tr_b16 v[104:105], v19 offset:4096
    ds_read_b64_tr_b16 v[106:107], v19 offset:4608
    v_mfma_f32_16x16x32_bf16 v[156:159], v[48:51], v[76:79], v[156:159]
    ds_read_b128 v[80:83], v16
    ds_read_b128 v[84:87], v16 offset:2048
    v_mfma_f32_16x16x32_bf16 v[116:119], v[68:71], v[48:51], v[116:119]
    ds_read_b128 v[88:91], v16 offset:4096
    ds_read_b128 v[92:95], v16 offset:6144
    v_mfma_f32_16x16x32_bf16 v[140:143], v[72:75], v[52:55], v[140:143]
    ds_read_b128 v[96:99], v16 offset:8192
    ds_read_b128 v[100:103], v18
    v_mfma_f32_16x16x32_bf16 v[160:163], v[52:55], v[76:79], v[160:163]
    v_mfma_f32_16x16x32_bf16 v[120:123], v[68:71], v[52:55], v[120:123]
    v_mfma_f32_16x16x32_bf16 v[144:147], v[72:75], v[56:59], v[144:147]
    v_mfma_f32_16x16x32_bf16 v[164:167], v[56:59], v[76:79], v[164:167]
    v_mfma_f32_16x16x32_bf16 v[124:127], v[68:71], v[56:59], v[124:127]
    v_mfma_f32_16x16x32_bf16 v[148:151], v[72:75], v[60:63], v[148:151]
    v_mfma_f32_16x16x32_bf16 v[168:171], v[60:63], v[76:79], v[168:171]
    v_mfma_f32_16x16x32_bf16 v[128:131], v[68:71], v[60:63], v[128:131]
    v_mfma_f32_16x16x32_bf16 v[172:175], v[68:71], v[20:23], v[172:175]
    v_mfma_f32_16x16x32_bf16 v[176:179], v[72:75], v[20:23], v[176:179]
    v_mfma_f32_16x16x32_bf16 v[180:183], v[20:23], v[76:79], v[180:183]
    v_mfma_f32_16x16x32_bf16 v[188:191], v[20:23], v[60:63], v[188:191]
    v_mfma_f32_16x16x32_bf16 v[196:199], v[60:63], v[60:63], v[196:199]
    v_mfma_f32_16x16x32_bf16 v[184:187], v[20:23], v[64:67], v[184:187]
    v_mfma_f32_16x16x32_bf16 v[192:195], v[64:67], v[64:67], v[192:195]
    s_waitcnt lgkmcnt(0)
    v_mfma_f32_16x16x32_bf16 v[132:135], v[108:111], v[80:83], v[132:135]
    v_mfma_f32_16x16x32_bf16 v[152:155], v[80:83], v[112:115], v[152:155]
    v_mfma_f32_16x16x32_bf16 v[136:139], v[108:111], v[84:87], v[136:139]
    v_mfma_f32_16x16x32_bf16 v[156:159], v[84:87], v[112:115], v[156:159]
    v_mfma_f32_16x16x32_bf16 v[116:119], v[104:107], v[84:87], v[116:119]
    v_mfma_f32_16x16x32_bf16 v[140:143], v[108:111], v[88:91], v[140:143]
    v_mfma_f32_16x16x32_bf16 v[160:163], v[88:91], v[112:115], v[160:163]
    v_mfma_f32_16x16x32_bf16 v[120:123], v[104:107], v[88:91], v[120:123]
    v_mfma_f32_16x16x32_bf16 v[144:147], v[108:111], v[92:95], v[144:147]
    v_mfma_f32_16x16x32_bf16 v[164:167], v[92:95], v[112:115], v[164:167]
    v_mfma_f32_16x16x32_bf16 v[124:127], v[104:107], v[92:95], v[124:127]
    v_mfma_f32_16x16x32_bf16 v[148:151], v[108:111], v[96:99], v[148:151]
    v_mfma_f32_16x16x32_bf16 v[168:171], v[96:99], v[112:115], v[168:171]
    v_mfma_f32_16x16x32_bf16 v[128:131], v[104:107], v[96:99], v[128:131]
    v_mfma_f32_16x16x32_bf16 v[172:175], v[104:107], v[20:23], v[172:175]
    v_mfma_f32_16x16x32_bf16 v[176:179], v[108:111], v[20:23], v[176:179]
    v_mfma_f32_16x16x32_bf16 v[180:183], v[20:23], v[112:115], v[180:183]
    v_mfma_f32_16x16x32_bf16 v[188:191], v[20:23], v[96:99], v[188:191]
    v_mfma_f32_16x16x32_bf16 v[196:199], v[96:99], v[96:99], v[196:199]
    v_mfma_f32_16x16x32_bf16 v[184:187], v[20:23], v[100:103], v[184:187]
    v_mfma_f32_16x16x32_bf16 v[192:195], v[100:103], v[100:103], v[192:195]
    s_nop 7
    v_cndmask_b32 v202, v192, v193, s[62:63]
    v_cndmask_b32 v203, v196, v197, s[62:63]
    v_cndmask_b32 v202, v202, v194, s[64:65]
    v_cndmask_b32 v203, v203, v198, s[64:65]
    v_cndmask_b32 v202, v202, v195, s[66:67]
    v_cndmask_b32 v203, v203, v199, s[66:67]
    v_mul_f32 v200, 0x3b000000, v184
    v_mul_f32 v201, 0x3b000000, v188
    v_mul_f32 v202, 0x3b000000, v202
    v_mul_f32 v203, 0x3b000000, v203
    v_fma_f32 v202, -v200, v200, v202
    v_fma_f32 v203, -v201, v201, v203
    v_max_f32 v202, 0, v202
    v_max_f32 v203, 0, v203
    v_cvt_pk_bf16_f32 v5, v200, v202
    v_cvt_pk_bf16_f32 v6, v201, v203
    v_lshlrev_b32 v200, 16, v5
    v_lshlrev_b32 v201, 16, v6
    v_and_b32 v202, 4294901760, v5
    v_and_b32 v203, 4294901760, v6
    v_add_f32 v202, 0x3727c5ac, v202
    v_add_f32 v203, 0x3727c5ac, v203
    v_cvt_pk_bf16_f32 v5, v202, v202
    v_cvt_pk_bf16_f32 v6, v203, v203
    v_lshlrev_b32 v202, 16, v5
    v_lshlrev_b32 v203, 16, v6
    v_sqrt_f32 v202, v202
    v_sqrt_f32 v203, v203
    v_cvt_pk_bf16_f32 v5, v202, v202
    v_cvt_pk_bf16_f32 v6, v203, v203
    v_lshlrev_b32 v202, 16, v5
    v_lshlrev_b32 v203, 16, v6
    v_rcp_f32 v202, v202
    v_rcp_f32 v203, v203
    s_mov_b64 exec, s[68:69]
    ds_write_b32 v39, v200
    ds_write_b32 v39, v202 offset:320
    ds_write_b32 v40, v201
    ds_write_b32 v40, v203 offset:320
    s_mov_b64 exec, -1
    s_waitcnt lgkmcnt(0)
    s_barrier
    ds_read2_b32 v[44:45], v41 offset0:0 offset1:80
    ds_read_b128 v[80:83], v42
    ds_read_b128 v[68:71], v42 offset:320
    ds_read2_b32 v[48:49], v41 offset0:16 offset1:96
    ds_read_b128 v[84:87], v42 offset:64
    ds_read_b128 v[72:75], v42 offset:384
    ds_read2_b32 v[52:53], v41 offset0:32 offset1:112
    ds_read_b128 v[88:91], v42 offset:128
    ds_read_b128 v[76:79], v42 offset:448
    ds_read2_b32 v[56:57], v41 offset0:48 offset1:128
    ds_read_b128 v[92:95], v42 offset:192
    ds_read_b128 v[64:67], v42 offset:512
    ds_read2_b32 v[60:61], v41 offset0:64 offset1:144
    ds_read_b128 v[96:99], v42 offset:256
    ds_read_b128 v[100:103], v42 offset:576
    s_waitcnt lgkmcnt(0)
    v_pk_fma_f32 v[132:133], v[176:177], v[44:45], v[132:133] op_sel_hi:[1,0,1] neg_lo:[0,1,0] neg_hi:[0,1,0]
    v_pk_fma_f32 v[134:135], v[178:179], v[44:45], v[134:135] op_sel_hi:[1,0,1] neg_lo:[0,1,0] neg_hi:[0,1,0]
    v_pk_mul_f32 v[132:133], v[132:133], v[44:45] op_sel:[0,1] op_sel_hi:[1,1]
    v_pk_mul_f32 v[134:135], v[134:135], v[44:45] op_sel:[0,1] op_sel_hi:[1,1]
    v_cvt_pk_bf16_f32 v212, v132, v133
    v_cvt_pk_bf16_f32 v213, v134, v135
    v_pk_fma_f32 v[152:153], v[180:181], v[80:81], v[152:153] neg_lo:[0,1,0] neg_hi:[0,1,0]
    v_pk_fma_f32 v[154:155], v[182:183], v[82:83], v[154:155] neg_lo:[0,1,0] neg_hi:[0,1,0]
    v_pk_mul_f32 v[152:153], v[152:153], v[68:69]
    v_pk_mul_f32 v[154:155], v[154:155], v[70:71]
    v_cvt_pk_bf16_f32 v222, v152, v153
    v_cvt_pk_bf16_f32 v223, v154, v155
    v_pk_fma_f32 v[136:137], v[176:177], v[48:49], v[136:137] op_sel_hi:[1,0,1] neg_lo:[0,1,0] neg_hi:[0,1,0]
    v_pk_fma_f32 v[138:139], v[178:179], v[48:49], v[138:139] op_sel_hi:[1,0,1] neg_lo:[0,1,0] neg_hi:[0,1,0]
    v_pk_mul_f32 v[136:137], v[136:137], v[48:49] op_sel:[0,1] op_sel_hi:[1,1]
    v_pk_mul_f32 v[138:139], v[138:139], v[48:49] op_sel:[0,1] op_sel_hi:[1,1]
    v_cvt_pk_bf16_f32 v214, v136, v137
    v_cvt_pk_bf16_f32 v215, v138, v139
    v_pk_fma_f32 v[116:117], v[172:173], v[48:49], v[116:117] op_sel_hi:[1,0,1] neg_lo:[0,1,0] neg_hi:[0,1,0]
    v_pk_fma_f32 v[118:119], v[174:175], v[48:49], v[118:119] op_sel_hi:[1,0,1] neg_lo:[0,1,0] neg_hi:[0,1,0]
    v_pk_mul_f32 v[116:117], v[116:117], v[48:49] op_sel:[0,1] op_sel_hi:[1,1]
    v_pk_mul_f32 v[118:119], v[118:119], v[48:49] op_sel:[0,1] op_sel_hi:[1,1]
    v_cvt_pk_bf16_f32 v204, v116, v117
    v_cvt_pk_bf16_f32 v205, v118, v119
    v_pk_fma_f32 v[156:157], v[180:181], v[84:85], v[156:157] neg_lo:[0,1,0] neg_hi:[0,1,0]
    v_pk_fma_f32 v[158:159], v[182:183], v[86:87], v[158:159] neg_lo:[0,1,0] neg_hi:[0,1,0]
    v_pk_mul_f32 v[156:157], v[156:157], v[72:73]
    v_pk_mul_f32 v[158:159], v[158:159], v[74:75]
    v_cvt_pk_bf16_f32 v224, v156, v157
    v_cvt_pk_bf16_f32 v225, v158, v159
    v_pk_fma_f32 v[140:141], v[176:177], v[52:53], v[140:141] op_sel_hi:[1,0,1] neg_lo:[0,1,0] neg_hi:[0,1,0]
    v_pk_fma_f32 v[142:143], v[178:179], v[52:53], v[142:143] op_sel_hi:[1,0,1] neg_lo:[0,1,0] neg_hi:[0,1,0]
    v_pk_mul_f32 v[140:141], v[140:141], v[52:53] op_sel:[0,1] op_sel_hi:[1,1]
    v_pk_mul_f32 v[142:143], v[142:143], v[52:53] op_sel:[0,1] op_sel_hi:[1,1]
    v_cvt_pk_bf16_f32 v216, v140, v141
    v_cvt_pk_bf16_f32 v217, v142, v143
    v_pk_fma_f32 v[120:121], v[172:173], v[52:53], v[120:121] op_sel_hi:[1,0,1] neg_lo:[0,1,0] neg_hi:[0,1,0]
    v_pk_fma_f32 v[122:123], v[174:175], v[52:53], v[122:123] op_sel_hi:[1,0,1] neg_lo:[0,1,0] neg_hi:[0,1,0]
    v_pk_mul_f32 v[120:121], v[120:121], v[52:53] op_sel:[0,1] op_sel_hi:[1,1]
    v_pk_mul_f32 v[122:123], v[122:123], v[52:53] op_sel:[0,1] op_sel_hi:[1,1]
    v_cvt_pk_bf16_f32 v206, v120, v121
    v_cvt_pk_bf16_f32 v207, v122, v123
    v_pk_fma_f32 v[160:161], v[180:181], v[88:89], v[160:161] neg_lo:[0,1,0] neg_hi:[0,1,0]
    v_pk_fma_f32 v[162:163], v[182:183], v[90:91], v[162:163] neg_lo:[0,1,0] neg_hi:[0,1,0]
    v_pk_mul_f32 v[160:161], v[160:161], v[76:77]
    v_pk_mul_f32 v[162:163], v[162:163], v[78:79]
    v_cvt_pk_bf16_f32 v226, v160, v161
    v_cvt_pk_bf16_f32 v227, v162, v163
    v_pk_fma_f32 v[144:145], v[176:177], v[56:57], v[144:145] op_sel_hi:[1,0,1] neg_lo:[0,1,0] neg_hi:[0,1,0]
    v_pk_fma_f32 v[146:147], v[178:179], v[56:57], v[146:147] op_sel_hi:[1,0,1] neg_lo:[0,1,0] neg_hi:[0,1,0]
    v_pk_mul_f32 v[144:145], v[144:145], v[56:57] op_sel:[0,1] op_sel_hi:[1,1]
    v_pk_mul_f32 v[146:147], v[146:147], v[56:57] op_sel:[0,1] op_sel_hi:[1,1]
    v_cvt_pk_bf16_f32 v218, v144, v145
    v_cvt_pk_bf16_f32 v219, v146, v147
    v_pk_fma_f32 v[124:125], v[172:173], v[56:57], v[124:125] op_sel_hi:[1,0,1] neg_lo:[0,1,0] neg_hi:[0,1,0]
    v_pk_fma_f32 v[126:127], v[174:175], v[56:57], v[126:127] op_sel_hi:[1,0,1] neg_lo:[0,1,0] neg_hi:[0,1,0]
    v_pk_mul_f32 v[124:125], v[124:125], v[56:57] op_sel:[0,1] op_sel_hi:[1,1]
    v_pk_mul_f32 v[126:127], v[126:127], v[56:57] op_sel:[0,1] op_sel_hi:[1,1]
    v_cvt_pk_bf16_f32 v208, v124, v125
    v_cvt_pk_bf16_f32 v209, v126, v127
    v_pk_fma_f32 v[164:165], v[180:181], v[92:93], v[164:165] neg_lo:[0,1,0] neg_hi:[0,1,0]
    v_pk_fma_f32 v[166:167], v[182:183], v[94:95], v[166:167] neg_lo:[0,1,0] neg_hi:[0,1,0]
    v_pk_mul_f32 v[164:165], v[164:165], v[64:65]
    v_pk_mul_f32 v[166:167], v[166:167], v[66:67]
    v_cvt_pk_bf16_f32 v228, v164, v165
    v_cvt_pk_bf16_f32 v229, v166, v167
    v_pk_fma_f32 v[148:149], v[176:177], v[60:61], v[148:149] op_sel_hi:[1,0,1] neg_lo:[0,1,0] neg_hi:[0,1,0]
    v_pk_fma_f32 v[150:151], v[178:179], v[60:61], v[150:151] op_sel_hi:[1,0,1] neg_lo:[0,1,0] neg_hi:[0,1,0]
    v_pk_mul_f32 v[148:149], v[148:149], v[60:61] op_sel:[0,1] op_sel_hi:[1,1]
    v_pk_mul_f32 v[150:151], v[150:151], v[60:61] op_sel:[0,1] op_sel_hi:[1,1]
    v_cvt_pk_bf16_f32 v220, v148, v149
    v_cvt_pk_bf16_f32 v221, v150, v151
    v_pk_fma_f32 v[128:129], v[172:173], v[60:61], v[128:129] op_sel_hi:[1,0,1] neg_lo:[0,1,0] neg_hi:[0,1,0]
    v_pk_fma_f32 v[130:131], v[174:175], v[60:61], v[130:131] op_sel_hi:[1,0,1] neg_lo:[0,1,0] neg_hi:[0,1,0]
    v_pk_mul_f32 v[128:129], v[128:129], v[60:61] op_sel:[0,1] op_sel_hi:[1,1]
    v_pk_mul_f32 v[130:131], v[130:131], v[60:61] op_sel:[0,1] op_sel_hi:[1,1]
    v_cvt_pk_bf16_f32 v210, v128, v129
    v_cvt_pk_bf16_f32 v211, v130, v131
    v_pk_fma_f32 v[168:169], v[180:181], v[96:97], v[168:169] neg_lo:[0,1,0] neg_hi:[0,1,0]
    v_pk_fma_f32 v[170:171], v[182:183], v[98:99], v[170:171] neg_lo:[0,1,0] neg_hi:[0,1,0]
    v_pk_mul_f32 v[168:169], v[168:169], v[100:101]
    v_pk_mul_f32 v[170:171], v[170:171], v[102:103]
    v_cvt_pk_bf16_f32 v230, v168, v169
    v_cvt_pk_bf16_f32 v231, v170, v171
    v_mfma_f32_16x16x16_bf16 v[116:119], v[212:213], v[204:205], 0
    v_mfma_f32_16x16x16_bf16 v[132:135], v[214:215], v[204:205], 0
    v_mfma_f32_16x16x16_bf16 v[120:123], v[214:215], v[206:207], 0
    v_mfma_f32_16x16x16_bf16 v[136:139], v[216:217], v[206:207], 0
    v_mfma_f32_16x16x16_bf16 v[124:127], v[216:217], v[208:209], 0
    v_mfma_f32_16x16x16_bf16 v[140:143], v[218:219], v[208:209], 0
    v_mfma_f32_16x16x16_bf16 v[128:131], v[218:219], v[210:211], 0
    v_mfma_f32_16x16x16_bf16 v[144:147], v[220:221], v[210:211], 0
    s_nop 0
    v_pk_fma_f32 v[116:117], v[116:117], s[72:73], v[34:35]
    v_pk_fma_f32 v[132:133], v[132:133], s[72:73], v[28:29]
    v_pk_fma_f32 v[118:119], v[118:119], s[72:73], v[36:37]
    v_pk_fma_f32 v[134:135], v[134:135], s[72:73], v[30:31]
    v_pk_fma_f32 v[120:121], v[120:121], s[72:73], v[24:25]
    v_pk_fma_f32 v[136:137], v[136:137], s[72:73], v[28:29]
    v_pk_fma_f32 v[122:123], v[122:123], s[72:73], v[26:27]
    v_pk_fma_f32 v[138:139], v[138:139], s[72:73], v[30:31]
    v_pk_fma_f32 v[124:125], v[124:125], s[72:73], v[24:25]
    v_pk_fma_f32 v[140:141], v[140:141], s[72:73], v[28:29]
    v_pk_fma_f32 v[126:127], v[126:127], s[72:73], v[26:27]
    v_pk_fma_f32 v[142:143], v[142:143], s[72:73], v[30:31]
    v_pk_fma_f32 v[128:129], v[128:129], s[72:73], v[24:25]
    v_pk_fma_f32 v[144:145], v[144:145], s[72:73], v[28:29]
    v_pk_fma_f32 v[130:131], v[130:131], s[72:73], v[26:27]
    v_pk_fma_f32 v[146:147], v[146:147], s[72:73], v[30:31]
    v_max3_f32 v232, v116, v117, v118
    v_max3_f32 v234, v120, v121, v122
    v_max3_f32 v236, v124, v125, v126
    v_max3_f32 v238, v128, v129, v130
    v_max3_f32 v232, v232, v119, v132
    v_max3_f32 v234, v234, v123, v136
    v_max3_f32 v236, v236, v127, v140
    v_max3_f32 v238, v238, v131, v144
    v_max3_f32 v232, v232, v133, v134
    v_max3_f32 v234, v234, v137, v138
    v_max3_f32 v236, v236, v141, v142
    v_max3_f32 v238, v238, v145, v146
    v_max_f32 v232, v232, v135
    v_max_f32 v234, v234, v139
    v_max_f32 v236, v236, v143
    v_max_f32 v238, v238, v147
    v_mov_b32 v233, v232
    v_mov_b32 v235, v234
    v_mov_b32 v237, v236
    v_mov_b32 v239, v238
    v_permlane32_swap_b32 v232, v233
    v_permlane32_swap_b32 v234, v235
    v_permlane32_swap_b32 v236, v237
    v_permlane32_swap_b32 v238, v239
    v_max_f32 v232, v232, v233
    v_max_f32 v234, v234, v235
    v_max_f32 v236, v236, v237
    v_max_f32 v238, v238, v239
    v_mov_b32 v233, v232
    v_mov_b32 v235, v234
    v_mov_b32 v237, v236
    v_mov_b32 v239, v238
    v_permlane16_swap_b32 v232, v233
    v_permlane16_swap_b32 v234, v235
    v_permlane16_swap_b32 v236, v237
    v_permlane16_swap_b32 v238, v239
    v_max_f32 v232, v232, v233
    v_max_f32 v234, v234, v235
    v_max_f32 v236, v236, v237
    v_max_f32 v238, v238, v239
    v_pk_add_f32 v[116:117], v[116:117], v[232:233] op_sel_hi:[1,0] neg_lo:[0,1] neg_hi:[0,1]
    v_pk_add_f32 v[118:119], v[118:119], v[232:233] op_sel_hi:[1,0] neg_lo:[0,1] neg_hi:[0,1]
    v_pk_add_f32 v[132:133], v[132:133], v[232:233] op_sel_hi:[1,0] neg_lo:[0,1] neg_hi:[0,1]
    v_pk_add_f32 v[134:135], v[134:135], v[232:233] op_sel_hi:[1,0] neg_lo:[0,1] neg_hi:[0,1]
    v_pk_add_f32 v[120:121], v[120:121], v[234:235] op_sel_hi:[1,0] neg_lo:[0,1] neg_hi:[0,1]
    v_pk_add_f32 v[122:123], v[122:123], v[234:235] op_sel_hi:[1,0] neg_lo:[0,1] neg_hi:[0,1]
    v_pk_add_f32 v[136:137], v[136:137], v[234:235] op_sel_hi:[1,0] neg_lo:[0,1] neg_hi:[0,1]
    v_pk_add_f32 v[138:139], v[138:139], v[234:235] op_sel_hi:[1,0] neg_lo:[0,1] neg_hi:[0,1]
    v_pk_add_f32 v[124:125], v[124:125], v[236:237] op_sel_hi:[1,0] neg_lo:[0,1] neg_hi:[0,1]
    v_pk_add_f32 v[126:127], v[126:127], v[236:237] op_sel_hi:[1,0] neg_lo:[0,1] neg_hi:[0,1]
    v_pk_add_f32 v[140:141], v[140:141], v[236:237] op_sel_hi:[1,0] neg_lo:[0,1] neg_hi:[0,1]
    v_pk_add_f32 v[142:143], v[142:143], v[236:237] op_sel_hi:[1,0] neg_lo:[0,1] neg_hi:[0,1]
    v_pk_add_f32 v[128:129], v[128:129], v[238:239] op_sel_hi:[1,0] neg_lo:[0,1] neg_hi:[0,1]
    v_pk_add_f32 v[130:131], v[130:131], v[238:239] op_sel_hi:[1,0] neg_lo:[0,1] neg_hi:[0,1]
    v_pk_add_f32 v[144:145], v[144:145], v[238:239] op_sel_hi:[1,0] neg_lo:[0,1] neg_hi:[0,1]
    v_pk_add_f32 v[146:147], v[146:147], v[238:239] op_sel_hi:[1,0] neg_lo:[0,1] neg_hi:[0,1]
    v_exp_f32 v116, v116
    v_exp_f32 v117, v117
    v_exp_f32 v118, v118
    v_exp_f32 v119, v119
    v_exp_f32 v132, v132
    v_exp_f32 v133, v133
    v_exp_f32 v134, v134
    v_exp_f32 v135, v135
    v_exp_f32 v120, v120
    v_exp_f32 v121, v121
    v_exp_f32 v122, v122
    v_exp_f32 v123, v123
    v_exp_f32 v136, v136
    v_exp_f32 v137, v137
    v_exp_f32 v138, v138
    v_exp_f32 v139, v139
    v_exp_f32 v124, v124
    v_exp_f32 v125, v125
    v_exp_f32 v126, v126
    v_exp_f32 v127, v127
    v_exp_f32 v140, v140
    v_exp_f32 v141, v141
    v_exp_f32 v142, v142
    v_exp_f32 v143, v143
    v_exp_f32 v128, v128
    v_exp_f32 v129, v129
    v_exp_f32 v130, v130
    v_exp_f32 v131, v131
    v_exp_f32 v144, v144
    v_exp_f32 v145, v145
    v_exp_f32 v146, v146
    v_exp_f32 v147, v147
    v_pk_add_f32 v[248:249], v[116:117], v[118:119]
    v_pk_add_f32 v[250:251], v[120:121], v[122:123]
    v_pk_add_f32 v[252:253], v[124:125], v[126:127]
    v_pk_add_f32 v[254:255], v[128:129], v[130:131]
    v_pk_add_f32 v[240:241], v[132:133], v[134:135]
    v_pk_add_f32 v[242:243], v[136:137], v[138:139]
    v_pk_add_f32 v[244:245], v[140:141], v[142:143]
    v_pk_add_f32 v[246:247], v[144:145], v[146:147]
    v_pk_add_f32 v[240:241], v[240:241], v[248:249]
    v_pk_add_f32 v[242:243], v[242:243], v[250:251]
    v_pk_add_f32 v[244:245], v[244:245], v[252:253]
    v_pk_add_f32 v[246:247], v[246:247], v[254:255]
    v_add_f32 v240, v240, v241
    v_add_f32 v242, v242, v243
    v_add_f32 v244, v244, v245
    v_add_f32 v246, v246, v247
    v_mov_b32 v241, v240
    v_mov_b32 v243, v242
    v_mov_b32 v245, v244
    v_mov_b32 v247, v246
    v_permlane32_swap_b32 v240, v241
    v_permlane32_swap_b32 v242, v243
    v_permlane32_swap_b32 v244, v245
    v_permlane32_swap_b32 v246, v247
    v_add_f32 v240, v240, v241
    v_add_f32 v242, v242, v243
    v_add_f32 v244, v244, v245
    v_add_f32 v246, v246, v247
    v_mov_b32 v241, v240
    v_mov_b32 v243, v242
    v_mov_b32 v245, v244
    v_mov_b32 v247, v246
    v_permlane16_swap_b32 v240, v241
    v_permlane16_swap_b32 v242, v243
    v_permlane16_swap_b32 v244, v245
    v_permlane16_swap_b32 v246, v247
    v_add_f32 v240, v240, v241
    v_add_f32 v242, v242, v243
    v_add_f32 v244, v244, v245
    v_add_f32 v246, v246, v247
    v_rcp_f32 v240, v240
    v_rcp_f32 v242, v242
    v_rcp_f32 v244, v244
    v_rcp_f32 v246, v246
    v_pk_mul_f32 v[116:117], v[116:117], v[240:241] op_sel_hi:[1,0]
    v_pk_mul_f32 v[118:119], v[118:119], v[240:241] op_sel_hi:[1,0]
    v_pk_mul_f32 v[132:133], v[132:133], v[240:241] op_sel_hi:[1,0]
    v_pk_mul_f32 v[134:135], v[134:135], v[240:241] op_sel_hi:[1,0]
    v_pk_mul_f32 v[120:121], v[120:121], v[242:243] op_sel_hi:[1,0]
    v_pk_mul_f32 v[122:123], v[122:123], v[242:243] op_sel_hi:[1,0]
    v_pk_mul_f32 v[136:137], v[136:137], v[242:243] op_sel_hi:[1,0]
    v_pk_mul_f32 v[138:139], v[138:139], v[242:243] op_sel_hi:[1,0]
    v_pk_mul_f32 v[124:125], v[124:125], v[244:245] op_sel_hi:[1,0]
    v_pk_mul_f32 v[126:127], v[126:127], v[244:245] op_sel_hi:[1,0]
    v_pk_mul_f32 v[140:141], v[140:141], v[244:245] op_sel_hi:[1,0]
    v_pk_mul_f32 v[142:143], v[142:143], v[244:245] op_sel_hi:[1,0]
    v_pk_mul_f32 v[128:129], v[128:129], v[246:247] op_sel_hi:[1,0]
    v_pk_mul_f32 v[130:131], v[130:131], v[246:247] op_sel_hi:[1,0]
    v_pk_mul_f32 v[144:145], v[144:145], v[246:247] op_sel_hi:[1,0]
    v_pk_mul_f32 v[146:147], v[146:147], v[246:247] op_sel_hi:[1,0]
    v_cvt_pk_bf16_f32 v116, v116, v117
    v_cvt_pk_bf16_f32 v117, v118, v119
    v_cvt_pk_bf16_f32 v132, v132, v133
    v_cvt_pk_bf16_f32 v133, v134, v135
    v_cvt_pk_bf16_f32 v120, v120, v121
    v_cvt_pk_bf16_f32 v121, v122, v123
    v_cvt_pk_bf16_f32 v136, v136, v137
    v_cvt_pk_bf16_f32 v137, v138, v139
    v_cvt_pk_bf16_f32 v124, v124, v125
    v_cvt_pk_bf16_f32 v125, v126, v127
    v_cvt_pk_bf16_f32 v140, v140, v141
    v_cvt_pk_bf16_f32 v141, v142, v143
    v_cvt_pk_bf16_f32 v128, v128, v129
    v_cvt_pk_bf16_f32 v129, v130, v131
    v_cvt_pk_bf16_f32 v144, v144, v145
    v_cvt_pk_bf16_f32 v145, v146, v147
    v_mfma_f32_16x16x16_bf16 v[152:155], v[222:223], v[116:117], 0
    v_mfma_f32_16x16x16_bf16 v[156:159], v[224:225], v[120:121], 0
    v_mfma_f32_16x16x16_bf16 v[160:163], v[226:227], v[124:125], 0
    v_mfma_f32_16x16x16_bf16 v[164:167], v[228:229], v[128:129], 0
    v_mfma_f32_16x16x16_bf16 v[152:155], v[224:225], v[132:133], v[152:155]
    v_mfma_f32_16x16x16_bf16 v[156:159], v[226:227], v[136:137], v[156:159]
    v_mfma_f32_16x16x16_bf16 v[160:163], v[228:229], v[140:141], v[160:163]
    v_mfma_f32_16x16x16_bf16 v[164:167], v[230:231], v[144:145], v[164:167]
    s_nop 4
    v_cvt_pk_bf16_f32 v152, v152, v153
    v_cvt_pk_bf16_f32 v153, v154, v155
    s_mov_b32 s71, 0
    buffer_store_dwordx2 v[152:153], v38, s[52:55], s71 offen
    v_cvt_pk_bf16_f32 v156, v156, v157
    v_cvt_pk_bf16_f32 v157, v158, v159
    s_mov_b32 s71, 16384
    buffer_store_dwordx2 v[156:157], v38, s[52:55], s71 offen
    v_cvt_pk_bf16_f32 v160, v160, v161
    v_cvt_pk_bf16_f32 v161, v162, v163
    s_mov_b32 s71, 32768
    buffer_store_dwordx2 v[160:161], v38, s[52:55], s71 offen
    v_cvt_pk_bf16_f32 v164, v164, v165
    v_cvt_pk_bf16_f32 v165, v166, v167
    s_mov_b32 s71, 49152
    buffer_store_dwordx2 v[164:165], v38, s[52:55], s71 offen
    s_endpgm
L_sequential_preLN__sliding_local_dilated__mixer_channel_mlp__prompt_k1_kernel_loader:
    s_sub_u32 s58, s3, 4
    v_lshrrev_b32 v3, 3, v1
    v_and_b32 v4, 7, v1
    v_xor_b32 v5, v4, v3
    v_lshlrev_b32 v5, 4, v5
    s_add_u32 s60, s58, 0
    s_min_u32 s60, s60, 9
    s_lshl_b32 s63, s56, 6
    s_lshl_b32 s64, s60, 3
    s_add_u32 s63, s63, s64
    s_sub_u32 s63, s63, 16
    v_add_u32 v6, s63, v3
    v_max_i32 v6, 0, v6
    v_lshl_add_u32 v7, v6, 10, v5
    s_lshl_b32 s60, s60, 10
    s_add_u32 s61, s58, 4
    s_min_u32 s61, s61, 9
    s_lshl_b32 s63, s56, 6
    s_lshl_b32 s64, s61, 3
    s_add_u32 s63, s63, s64
    s_sub_u32 s63, s63, 16
    v_add_u32 v6, s63, v3
    v_max_i32 v6, 0, v6
    v_lshl_add_u32 v8, v6, 10, v5
    s_lshl_b32 s61, s61, 10
    s_add_u32 s62, s58, 8
    s_min_u32 s62, s62, 9
    s_lshl_b32 s63, s56, 6
    s_lshl_b32 s64, s62, 3
    s_add_u32 s63, s63, s64
    s_sub_u32 s63, s63, 16
    v_add_u32 v6, s63, v3
    v_max_i32 v6, 0, v6
    v_lshl_add_u32 v9, v6, 10, v5
    s_lshl_b32 s62, s62, 10
    s_lshl_b32 s65, s58, 11
    s_mov_b32 s66, 3072
    v_and_b32 v6, 2, v3
    v_xor_b32 v6, v6, v4
    v_lshlrev_b32 v6, 4, v6
    s_lshl_b32 s63, s58, 4
    s_add_u32 s63, s63, 0
    v_add_u32 v10, s63, v3
    v_mul_lo_u32 v10, v10, s66
    v_add_u32 v10, v10, v6
    s_lshl_b32 s63, s57, 7
    v_add_u32 v10, s63, v10
    v_and_b32 v6, 2, v3
    v_or_b32 v6, 4, v6
    v_xor_b32 v6, v6, v4
    v_lshlrev_b32 v6, 4, v6
    s_lshl_b32 s63, s58, 4
    s_add_u32 s63, s63, 8
    v_add_u32 v11, s63, v3
    v_mul_lo_u32 v11, v11, s66
    v_add_u32 v11, v11, v6
    s_lshl_b32 s63, s57, 7
    v_add_u32 v11, s63, v11
    s_waitcnt lgkmcnt(0)
    s_mov_b32 s36, s16
    s_and_b32 s37, s17, 65535
    s_mov_b32 s38, 2097152
    s_mov_b32 s39, 131072
    s_mov_b32 s40, s18
    s_and_b32 s41, s19, 65535
    s_mov_b32 s42, 1572864
    s_mov_b32 s43, 131072
    s_mov_b32 s52, s34
    s_and_b32 s53, s35, 65535
    s_mov_b32 s54, 2097152
    s_mov_b32 s55, 131072
    s_and_b32 s68, s2, 7
    s_mul_i32 s68, s68, 8
    s_lshr_b32 s68, s68, 3
    s_add_u32 m0, s65, 10240
    s_mul_i32 s67, s68, 196608
    buffer_load_dwordx4 v10, s[40:43], s67 offen lds
    s_add_u32 m0, s65, 11264
    s_mul_i32 s67, s68, 196608
    buffer_load_dwordx4 v11, s[40:43], s67 offen lds
    s_add_u32 m0, s65, 18432
    s_mul_i32 s67, s68, 196608
    s_add_u32 s67, s67, 1024
    buffer_load_dwordx4 v10, s[40:43], s67 offen lds
    s_add_u32 m0, s65, 19456
    s_mul_i32 s67, s68, 196608
    s_add_u32 s67, s67, 1024
    buffer_load_dwordx4 v11, s[40:43], s67 offen lds
    s_add_u32 m0, s65, 26624
    s_mul_i32 s67, s68, 196608
    s_add_u32 s67, s67, 2048
    buffer_load_dwordx4 v10, s[40:43], s67 offen lds
    s_add_u32 m0, s65, 27648
    s_mul_i32 s67, s68, 196608
    s_add_u32 s67, s67, 2048
    buffer_load_dwordx4 v11, s[40:43], s67 offen lds
    s_add_u32 m0, s60, 0
    s_lshl_b32 s67, s68, 7
    buffer_load_dwordx4 v7, s[36:39], s67 offen lds
    s_add_u32 m0, s61, 0
    s_lshl_b32 s67, s68, 7
    buffer_load_dwordx4 v8, s[36:39], s67 offen lds
    s_add_u32 m0, s62, 0
    s_lshl_b32 s67, s68, 7
    buffer_load_dwordx4 v9, s[36:39], s67 offen lds
    s_add_u32 s68, s68, 1
    s_cmp_ge_u32 s68, 8
    s_cselect_b32 s68, 0, s68
    s_add_u32 m0, s65, 45056
    s_mul_i32 s67, s68, 196608
    buffer_load_dwordx4 v10, s[40:43], s67 offen lds
    s_add_u32 m0, s65, 46080
    s_mul_i32 s67, s68, 196608
    buffer_load_dwordx4 v11, s[40:43], s67 offen lds
    s_add_u32 m0, s65, 53248
    s_mul_i32 s67, s68, 196608
    s_add_u32 s67, s67, 1024
    buffer_load_dwordx4 v10, s[40:43], s67 offen lds
    s_add_u32 m0, s65, 54272
    s_mul_i32 s67, s68, 196608
    s_add_u32 s67, s67, 1024
    buffer_load_dwordx4 v11, s[40:43], s67 offen lds
    s_add_u32 m0, s65, 61440
    s_mul_i32 s67, s68, 196608
    s_add_u32 s67, s67, 2048
    buffer_load_dwordx4 v10, s[40:43], s67 offen lds
    s_add_u32 m0, s65, 62464
    s_mul_i32 s67, s68, 196608
    s_add_u32 s67, s67, 2048
    buffer_load_dwordx4 v11, s[40:43], s67 offen lds
    s_add_u32 m0, s60, 34816
    s_lshl_b32 s67, s68, 7
    buffer_load_dwordx4 v7, s[36:39], s67 offen lds
    s_add_u32 m0, s61, 34816
    s_lshl_b32 s67, s68, 7
    buffer_load_dwordx4 v8, s[36:39], s67 offen lds
    s_add_u32 m0, s62, 34816
    s_lshl_b32 s67, s68, 7
    buffer_load_dwordx4 v9, s[36:39], s67 offen lds
    s_add_u32 s68, s68, 1
    s_cmp_ge_u32 s68, 8
    s_cselect_b32 s68, 0, s68
    s_waitcnt vmcnt(9)
    s_barrier
    s_add_u32 m0, s65, 79872
    s_mul_i32 s67, s68, 196608
    buffer_load_dwordx4 v10, s[40:43], s67 offen lds
    s_add_u32 m0, s65, 80896
    s_mul_i32 s67, s68, 196608
    buffer_load_dwordx4 v11, s[40:43], s67 offen lds
    s_add_u32 m0, s65, 88064
    s_mul_i32 s67, s68, 196608
    s_add_u32 s67, s67, 1024
    buffer_load_dwordx4 v10, s[40:43], s67 offen lds
    s_add_u32 m0, s65, 89088
    s_mul_i32 s67, s68, 196608
    s_add_u32 s67, s67, 1024
    buffer_load_dwordx4 v11, s[40:43], s67 offen lds
    s_add_u32 m0, s65, 96256
    s_mul_i32 s67, s68, 196608
    s_add_u32 s67, s67, 2048
    buffer_load_dwordx4 v10, s[40:43], s67 offen lds
    s_add_u32 m0, s65, 97280
    s_mul_i32 s67, s68, 196608
    s_add_u32 s67, s67, 2048
    buffer_load_dwordx4 v11, s[40:43], s67 offen lds
    s_add_u32 m0, s60, 69632
    s_lshl_b32 s67, s68, 7
    buffer_load_dwordx4 v7, s[36:39], s67 offen lds
    s_add_u32 m0, s61, 69632
    s_lshl_b32 s67, s68, 7
    buffer_load_dwordx4 v8, s[36:39], s67 offen lds
    s_add_u32 m0, s62, 69632
    s_lshl_b32 s67, s68, 7
    buffer_load_dwordx4 v9, s[36:39], s67 offen lds
    s_add_u32 s68, s68, 1
    s_cmp_ge_u32 s68, 8
    s_cselect_b32 s68, 0, s68
    s_add_u32 m0, s65, 114688
    s_mul_i32 s67, s68, 196608
    buffer_load_dwordx4 v10, s[40:43], s67 offen lds
    s_add_u32 m0, s65, 115712
    s_mul_i32 s67, s68, 196608
    buffer_load_dwordx4 v11, s[40:43], s67 offen lds
    s_add_u32 m0, s65, 122880
    s_mul_i32 s67, s68, 196608
    s_add_u32 s67, s67, 1024
    buffer_load_dwordx4 v10, s[40:43], s67 offen lds
    s_add_u32 m0, s65, 123904
    s_mul_i32 s67, s68, 196608
    s_add_u32 s67, s67, 1024
    buffer_load_dwordx4 v11, s[40:43], s67 offen lds
    s_add_u32 m0, s65, 131072
    s_mul_i32 s67, s68, 196608
    s_add_u32 s67, s67, 2048
    buffer_load_dwordx4 v10, s[40:43], s67 offen lds
    s_add_u32 m0, s65, 132096
    s_mul_i32 s67, s68, 196608
    s_add_u32 s67, s67, 2048
    buffer_load_dwordx4 v11, s[40:43], s67 offen lds
    s_add_u32 m0, s60, 104448
    s_lshl_b32 s67, s68, 7
    buffer_load_dwordx4 v7, s[36:39], s67 offen lds
    s_add_u32 m0, s61, 104448
    s_lshl_b32 s67, s68, 7
    buffer_load_dwordx4 v8, s[36:39], s67 offen lds
    s_add_u32 m0, s62, 104448
    s_lshl_b32 s67, s68, 7
    buffer_load_dwordx4 v9, s[36:39], s67 offen lds
    s_add_u32 s68, s68, 1
    s_cmp_ge_u32 s68, 8
    s_cselect_b32 s68, 0, s68
    s_waitcnt vmcnt(18)
    s_barrier
    s_add_u32 m0, s65, 10240
    s_mul_i32 s67, s68, 196608
    buffer_load_dwordx4 v10, s[40:43], s67 offen lds
    s_add_u32 m0, s65, 11264
    s_mul_i32 s67, s68, 196608
    buffer_load_dwordx4 v11, s[40:43], s67 offen lds
    s_add_u32 m0, s65, 18432
    s_mul_i32 s67, s68, 196608
    s_add_u32 s67, s67, 1024
    buffer_load_dwordx4 v10, s[40:43], s67 offen lds
    s_add_u32 m0, s65, 19456
    s_mul_i32 s67, s68, 196608
    s_add_u32 s67, s67, 1024
    buffer_load_dwordx4 v11, s[40:43], s67 offen lds
    s_add_u32 m0, s65, 26624
    s_mul_i32 s67, s68, 196608
    s_add_u32 s67, s67, 2048
    buffer_load_dwordx4 v10, s[40:43], s67 offen lds
    s_add_u32 m0, s65, 27648
    s_mul_i32 s67, s68, 196608
    s_add_u32 s67, s67, 2048
    buffer_load_dwordx4 v11, s[40:43], s67 offen lds
    s_add_u32 m0, s60, 0
    s_lshl_b32 s67, s68, 7
    buffer_load_dwordx4 v7, s[36:39], s67 offen lds
    s_add_u32 m0, s61, 0
    s_lshl_b32 s67, s68, 7
    buffer_load_dwordx4 v8, s[36:39], s67 offen lds
    s_add_u32 m0, s62, 0
    s_lshl_b32 s67, s68, 7
    buffer_load_dwordx4 v9, s[36:39], s67 offen lds
    s_add_u32 s68, s68, 1
    s_cmp_ge_u32 s68, 8
    s_cselect_b32 s68, 0, s68
    s_waitcnt vmcnt(18)
    s_barrier
    s_add_u32 m0, s65, 45056
    s_mul_i32 s67, s68, 196608
    buffer_load_dwordx4 v10, s[40:43], s67 offen lds
    s_add_u32 m0, s65, 46080
    s_mul_i32 s67, s68, 196608
    buffer_load_dwordx4 v11, s[40:43], s67 offen lds
    s_add_u32 m0, s65, 53248
    s_mul_i32 s67, s68, 196608
    s_add_u32 s67, s67, 1024
    buffer_load_dwordx4 v10, s[40:43], s67 offen lds
    s_add_u32 m0, s65, 54272
    s_mul_i32 s67, s68, 196608
    s_add_u32 s67, s67, 1024
    buffer_load_dwordx4 v11, s[40:43], s67 offen lds
    s_add_u32 m0, s65, 61440
    s_mul_i32 s67, s68, 196608
    s_add_u32 s67, s67, 2048
    buffer_load_dwordx4 v10, s[40:43], s67 offen lds
    s_add_u32 m0, s65, 62464
    s_mul_i32 s67, s68, 196608
    s_add_u32 s67, s67, 2048
    buffer_load_dwordx4 v11, s[40:43], s67 offen lds
    s_add_u32 m0, s60, 34816
    s_lshl_b32 s67, s68, 7
    buffer_load_dwordx4 v7, s[36:39], s67 offen lds
    s_add_u32 m0, s61, 34816
    s_lshl_b32 s67, s68, 7
    buffer_load_dwordx4 v8, s[36:39], s67 offen lds
    s_add_u32 m0, s62, 34816
    s_lshl_b32 s67, s68, 7
    buffer_load_dwordx4 v9, s[36:39], s67 offen lds
    s_add_u32 s68, s68, 1
    s_cmp_ge_u32 s68, 8
    s_cselect_b32 s68, 0, s68
    s_waitcnt vmcnt(18)
    s_barrier
    s_add_u32 m0, s65, 79872
    s_mul_i32 s67, s68, 196608
    buffer_load_dwordx4 v10, s[40:43], s67 offen lds
    s_add_u32 m0, s65, 80896
    s_mul_i32 s67, s68, 196608
    buffer_load_dwordx4 v11, s[40:43], s67 offen lds
    s_add_u32 m0, s65, 88064
    s_mul_i32 s67, s68, 196608
    s_add_u32 s67, s67, 1024
    buffer_load_dwordx4 v10, s[40:43], s67 offen lds
    s_add_u32 m0, s65, 89088
    s_mul_i32 s67, s68, 196608
    s_add_u32 s67, s67, 1024
    buffer_load_dwordx4 v11, s[40:43], s67 offen lds
    s_add_u32 m0, s65, 96256
    s_mul_i32 s67, s68, 196608
    s_add_u32 s67, s67, 2048
    buffer_load_dwordx4 v10, s[40:43], s67 offen lds
    s_add_u32 m0, s65, 97280
    s_mul_i32 s67, s68, 196608
    s_add_u32 s67, s67, 2048
    buffer_load_dwordx4 v11, s[40:43], s67 offen lds
    s_add_u32 m0, s60, 69632
    s_lshl_b32 s67, s68, 7
    buffer_load_dwordx4 v7, s[36:39], s67 offen lds
    s_add_u32 m0, s61, 69632
    s_lshl_b32 s67, s68, 7
    buffer_load_dwordx4 v8, s[36:39], s67 offen lds
    s_add_u32 m0, s62, 69632
    s_lshl_b32 s67, s68, 7
    buffer_load_dwordx4 v9, s[36:39], s67 offen lds
    s_add_u32 s68, s68, 1
    s_cmp_ge_u32 s68, 8
    s_cselect_b32 s68, 0, s68
    s_waitcnt vmcnt(18)
    s_barrier
    s_add_u32 m0, s65, 114688
    s_mul_i32 s67, s68, 196608
    buffer_load_dwordx4 v10, s[40:43], s67 offen lds
    s_add_u32 m0, s65, 115712
    s_mul_i32 s67, s68, 196608
    buffer_load_dwordx4 v11, s[40:43], s67 offen lds
    s_add_u32 m0, s65, 122880
    s_mul_i32 s67, s68, 196608
    s_add_u32 s67, s67, 1024
    buffer_load_dwordx4 v10, s[40:43], s67 offen lds
    s_add_u32 m0, s65, 123904
    s_mul_i32 s67, s68, 196608
    s_add_u32 s67, s67, 1024
    buffer_load_dwordx4 v11, s[40:43], s67 offen lds
    s_add_u32 m0, s65, 131072
    s_mul_i32 s67, s68, 196608
    s_add_u32 s67, s67, 2048
    buffer_load_dwordx4 v10, s[40:43], s67 offen lds
    s_add_u32 m0, s65, 132096
    s_mul_i32 s67, s68, 196608
    s_add_u32 s67, s67, 2048
    buffer_load_dwordx4 v11, s[40:43], s67 offen lds
    s_add_u32 m0, s60, 104448
    s_lshl_b32 s67, s68, 7
    buffer_load_dwordx4 v7, s[36:39], s67 offen lds
    s_add_u32 m0, s61, 104448
    s_lshl_b32 s67, s68, 7
    buffer_load_dwordx4 v8, s[36:39], s67 offen lds
    s_add_u32 m0, s62, 104448
    s_lshl_b32 s67, s68, 7
    buffer_load_dwordx4 v9, s[36:39], s67 offen lds
    s_add_u32 s68, s68, 1
    s_cmp_ge_u32 s68, 8
    s_cselect_b32 s68, 0, s68
    s_waitcnt vmcnt(18)
    s_barrier
    s_waitcnt vmcnt(9)
    s_barrier
    s_waitcnt vmcnt(0)
    s_barrier
    s_mov_b32 s44, s20
    s_and_b32 s45, s21, 65535
    s_mov_b32 s46, 524288
    s_mov_b32 s47, 131072
    s_mov_b32 s48, s24
    s_and_b32 s49, s25, 65535
    s_mov_b32 s50, 1835008
    s_mov_b32 s51, 131072
    s_mov_b32 s52, s28
    s_and_b32 s53, s29, 65535
    s_mov_b32 s54, 1835008
    s_mov_b32 s55, 131072
    s_lshl_b32 s63, s2, 2
    s_add_u32 s63, s63, s58
    s_lshl_b32 s64, s63, 9
    v_lshl_add_u32 v6, v1, 3, s64
    buffer_load_dwordx2 v[12:13], v6, s[44:47], 0 offen
    s_mul_i32 s64, s63, 1792
    v_lshl_add_u32 v6, v1, 4, s64
    buffer_load_dwordx4 v[16:19], v6, s[48:51], 0 offen
    buffer_load_dwordx4 v[20:23], v6, s[48:51], 0 offen offset:768
    buffer_load_dwordx4 v[24:27], v6, s[52:55], 0 offen
    buffer_load_dwordx4 v[28:31], v6, s[52:55], 0 offen offset:768
    s_nop 0
L_sequential_preLN__sliding_local_dilated__mixer_channel_mlp__prompt_k1_kernel_end:
    s_endpgm
.section .rodata,"a"
.p2align 6
.amdhsa_kernel sequential_preLN__sliding_local_dilated__mixer_channel_mlp__prompt_k1_kernel
  .amdhsa_next_free_vgpr 256
  .amdhsa_next_free_sgpr 74
  .amdhsa_accum_offset 256
  .amdhsa_group_segment_fixed_size 0
  .amdhsa_kernarg_size 88
  .amdhsa_user_sgpr_count 2
  .amdhsa_user_sgpr_kernarg_segment_ptr 1
  .amdhsa_system_sgpr_workgroup_id_x 1
.end_amdhsa_kernel
.text
.globl sequential_preLN__sliding_local_dilated__mixer_channel_mlp__prompt_k2_kernel
.p2align 8
.type sequential_preLN__sliding_local_dilated__mixer_channel_mlp__prompt_k2_kernel,@function
sequential_preLN__sliding_local_dilated__mixer_channel_mlp__prompt_k2_kernel:
    s_cmp_ge_u32 s2, 256
    s_nop 0
    s_cbranch_scc1 L_sequential_preLN__sliding_local_dilated__mixer_channel_mlp__prompt_k2_kernel_end
    s_load_dwordx16 s[16:31], s[0:1], 0
    s_load_dwordx2 s[32:33], s[0:1], 64
    s_load_dwordx2 s[34:35], s[0:1], 80
    v_lshrrev_b32 v2, 6, v0
    v_and_b32 v1, 63, v0
    v_readfirstlane_b32 s3, v2
    s_and_b32 s58, s2, 7
    s_lshl_b32 s56, s58, 2
    s_lshr_b32 s59, s2, 3
    s_and_b32 s60, s59, 3
    s_add_u32 s56, s56, s60
    s_lshr_b32 s57, s59, 2
    s_cmp_ge_u32 s3, 4
    s_nop 0
    s_cbranch_scc1 L_sequential_preLN__sliding_local_dilated__mixer_channel_mlp__prompt_k2_kernel_loader
    v_and_b32 v3, 15, v1
    v_lshrrev_b32 v4, 4, v1
    v_and_b32 v7, 7, v1
    s_and_b32 s59, s3, 1
    s_lshr_b32 s60, s3, 1
    s_lshl_b32 s58, s56, 6
    s_lshl_b32 s61, s59, 5
    s_add_u32 s58, s58, s61
    v_add_u32 v8, s58, v3
    v_lshlrev_b32 v8, 10, v8
    s_lshl_b32 s58, s57, 7
    s_lshl_b32 s61, s60, 6
    s_add_u32 s58, s58, s61
    v_lshl_add_u32 v9, v4, 3, s58
    v_add_u32 v8, v8, v9
    v_add_u32 v5, 0, v4
    v_xor_b32 v5, v5, v7
    v_lshlrev_b32 v5, 4, v5
    v_lshl_add_u32 v5, v3, 7, v5
    s_lshl_b32 s58, s59, 12
    v_add_u32 v10, s58, v5
    v_add_u32 v12, 65536, v10
    v_add_u32 v5, 4, v4
    v_xor_b32 v5, v5, v7
    v_lshlrev_b32 v5, 4, v5
    v_lshl_add_u32 v5, v3, 7, v5
    s_lshl_b32 s58, s59, 12
    v_add_u32 v11, s58, v5
    v_add_u32 v13, 65536, v11
    v_lshrrev_b32 v18, 2, v3
    v_and_b32 v19, 3, v3
    v_lshrrev_b32 v5, 1, v19
    s_lshl_b32 s58, s60, 2
    s_add_u32 s58, s58, 0
    v_add_u32 v5, s58, v5
    v_and_b32 v6, 2, v18
    v_xor_b32 v5, v5, v6
    v_and_b32 v6, 1, v4
    v_lshlrev_b32 v6, 2, v6
    v_xor_b32 v5, v5, v6
    v_lshlrev_b32 v5, 4, v5
    v_and_b32 v6, 1, v19
    v_lshl_add_u32 v5, v6, 3, v5
    v_lshl_add_u32 v6, v4, 3, v18
    v_lshl_add_u32 v5, v6, 7, v5
    v_add_u32 v14, 8192, v5
    v_add_u32 v16, 65536, v14
    v_lshrrev_b32 v5, 1, v19
    s_lshl_b32 s58, s60, 2
    s_add_u32 s58, s58, 2
    v_add_u32 v5, s58, v5
    v_and_b32 v6, 2, v18
    v_xor_b32 v5, v5, v6
    v_and_b32 v6, 1, v4
    v_lshlrev_b32 v6, 2, v6
    v_xor_b32 v5, v5, v6
    v_lshlrev_b32 v5, 4, v5
    v_and_b32 v6, 1, v19
    v_lshl_add_u32 v5, v6, 3, v5
    v_lshl_add_u32 v6, v4, 3, v18
    v_lshl_add_u32 v5, v6, 7, v5
    v_add_u32 v15, 8192, v5
    v_add_u32 v17, 65536, v15
    s_waitcnt lgkmcnt(0)
    s_mov_b32 s36, s34
    s_and_b32 s37, s35, 65535
    s_mov_b32 s38, 2097152
    s_mov_b32 s39, 131072
    s_mov_b32 s40, s20
    s_and_b32 s41, s21, 65535
    s_mov_b32 s42, 524288
    s_mov_b32 s43, 131072
    s_mov_b32 s44, s16
    s_and_b32 s45, s17, 65535
    s_mov_b32 s46, 2097152
    s_mov_b32 s47, 131072
    s_add_u32 s52, s34, 2097152
    s_addc_u32 s53, s35, 0
    s_and_b32 s53, s53, 65535
    s_mov_b32 s54, 2097152
    s_mov_b32 s55, 131072
    s_mov_b32 s62, 16384
    buffer_load_dwordx2 v[20:21], v8, s[44:47], 0 offen
    buffer_load_dwordx2 v[22:23], v8, s[44:47], s62 offen
    buffer_load_dwordx2 v[24:25], v8, s[44:47], 0 offen offset:32
    buffer_load_dwordx2 v[26:27], v8, s[44:47], s62 offen offset:32
    s_barrier
    ds_read_b64_tr_b16 v[36:37], v14
    ds_read_b64_tr_b16 v[38:39], v14 offset:512
    ds_read_b64_tr_b16 v[40:41], v15
    ds_read_b64_tr_b16 v[42:43], v15 offset:512
    ds_read_b128 v[28:31], v10
    ds_read_b128 v[32:35], v10 offset:2048
    s_waitcnt lgkmcnt(0)
    v_mfma_f32_16x16x32_bf16 v[60:63], v[36:39], v[28:31], 0
    ds_read_b64_tr_b16 v[52:53], v14 offset:4096
    ds_read_b64_tr_b16 v[54:55], v14 offset:4608
    v_mfma_f32_16x16x32_bf16 v[64:67], v[36:39], v[32:35], 0
    ds_read_b64_tr_b16 v[56:57], v15 offset:4096
    ds_read_b64_tr_b16 v[58:59], v15 offset:4608
    v_mfma_f32_16x16x32_bf16 v[68:71], v[40:43], v[28:31], 0
    ds_read_b128 v[44:47], v11
    ds_read_b128 v[48:51], v11 offset:2048
    v_mfma_f32_16x16x32_bf16 v[72:75], v[40:43], v[32:35], 0
    s_waitcnt lgkmcnt(0)
    s_barrier
    v_mfma_f32_16x16x32_bf16 v[60:63], v[52:55], v[44:47], v[60:63]
    ds_read_b64_tr_b16 v[36:37], v14 offset:16384
    ds_read_b64_tr_b16 v[38:39], v14 offset:16896
    v_mfma_f32_16x16x32_bf16 v[64:67], v[52:55], v[48:51], v[64:67]
    ds_read_b64_tr_b16 v[40:41], v15 offset:16384
    ds_read_b64_tr_b16 v[42:43], v15 offset:16896
    v_mfma_f32_16x16x32_bf16 v[68:71], v[56:59], v[44:47], v[68:71]
    ds_read_b128 v[28:31], v10 offset:16384
    ds_read_b128 v[32:35], v10 offset:18432
    v_mfma_f32_16x16x32_bf16 v[72:75], v[56:59], v[48:51], v[72:75]
    s_waitcnt lgkmcnt(0)
    v_mfma_f32_16x16x32_bf16 v[60:63], v[36:39], v[28:31], v[60:63]
    ds_read_b64_tr_b16 v[52:53], v14 offset:20480
    ds_read_b64_tr_b16 v[54:55], v14 offset:20992
    v_mfma_f32_16x16x32_bf16 v[64:67], v[36:39], v[32:35], v[64:67]
    ds_read_b64_tr_b16 v[56:57], v15 offset:20480
    ds_read_b64_tr_b16 v[58:59], v15 offset:20992
    v_mfma_f32_16x16x32_bf16 v[68:71], v[40:43], v[28:31], v[68:71]
    ds_read_b128 v[44:47], v11 offset:16384
    ds_read_b128 v[48:51], v11 offset:18432
    v_mfma_f32_16x16x32_bf16 v[72:75], v[40:43], v[32:35], v[72:75]
    s_waitcnt lgkmcnt(0)
    s_barrier
    v_mfma_f32_16x16x32_bf16 v[60:63], v[52:55], v[44:47], v[60:63]
    ds_read_b64_tr_b16 v[36:37], v14 offset:32768
    ds_read_b64_tr_b16 v[38:39], v14 offset:33280
    v_mfma_f32_16x16x32_bf16 v[64:67], v[52:55], v[48:51], v[64:67]
    ds_read_b64_tr_b16 v[40:41], v15 offset:32768
    ds_read_b64_tr_b16 v[42:43], v15 offset:33280
    v_mfma_f32_16x16x32_bf16 v[68:71], v[56:59], v[44:47], v[68:71]
    ds_read_b128 v[28:31], v10 offset:32768
    ds_read_b128 v[32:35], v10 offset:34816
    v_mfma_f32_16x16x32_bf16 v[72:75], v[56:59], v[48:51], v[72:75]
    s_waitcnt lgkmcnt(0)
    v_mfma_f32_16x16x32_bf16 v[60:63], v[36:39], v[28:31], v[60:63]
    ds_read_b64_tr_b16 v[52:53], v14 offset:36864
    ds_read_b64_tr_b16 v[54:55], v14 offset:37376
    v_mfma_f32_16x16x32_bf16 v[64:67], v[36:39], v[32:35], v[64:67]
    ds_read_b64_tr_b16 v[56:57], v15 offset:36864
    ds_read_b64_tr_b16 v[58:59], v15 offset:37376
    v_mfma_f32_16x16x32_bf16 v[68:71], v[40:43], v[28:31], v[68:71]
    ds_read_b128 v[44:47], v11 offset:32768
    ds_read_b128 v[48:51], v11 offset:34816
    v_mfma_f32_16x16x32_bf16 v[72:75], v[40:43], v[32:35], v[72:75]
    s_waitcnt lgkmcnt(0)
    s_barrier
    v_mfma_f32_16x16x32_bf16 v[60:63], v[52:55], v[44:47], v[60:63]
    ds_read_b64_tr_b16 v[36:37], v14 offset:49152
    ds_read_b64_tr_b16 v[38:39], v14 offset:49664
    v_mfma_f32_16x16x32_bf16 v[64:67], v[52:55], v[48:51], v[64:67]
    ds_read_b64_tr_b16 v[40:41], v15 offset:49152
    ds_read_b64_tr_b16 v[42:43], v15 offset:49664
    v_mfma_f32_16x16x32_bf16 v[68:71], v[56:59], v[44:47], v[68:71]
    ds_read_b128 v[28:31], v10 offset:49152
    ds_read_b128 v[32:35], v10 offset:51200
    v_mfma_f32_16x16x32_bf16 v[72:75], v[56:59], v[48:51], v[72:75]
    s_waitcnt lgkmcnt(0)
    v_mfma_f32_16x16x32_bf16 v[60:63], v[36:39], v[28:31], v[60:63]
    ds_read_b64_tr_b16 v[52:53], v14 offset:53248
    ds_read_b64_tr_b16 v[54:55], v14 offset:53760
    v_mfma_f32_16x16x32_bf16 v[64:67], v[36:39], v[32:35], v[64:67]
    ds_read_b64_tr_b16 v[56:57], v15 offset:53248
    ds_read_b64_tr_b16 v[58:59], v15 offset:53760
    v_mfma_f32_16x16x32_bf16 v[68:71], v[40:43], v[28:31], v[68:71]
    ds_read_b128 v[44:47], v11 offset:49152
    ds_read_b128 v[48:51], v11 offset:51200
    v_mfma_f32_16x16x32_bf16 v[72:75], v[40:43], v[32:35], v[72:75]
    s_waitcnt lgkmcnt(0)
    s_barrier
    v_mfma_f32_16x16x32_bf16 v[60:63], v[52:55], v[44:47], v[60:63]
    ds_read_b64_tr_b16 v[36:37], v16
    ds_read_b64_tr_b16 v[38:39], v16 offset:512
    v_mfma_f32_16x16x32_bf16 v[64:67], v[52:55], v[48:51], v[64:67]
    ds_read_b64_tr_b16 v[40:41], v17
    ds_read_b64_tr_b16 v[42:43], v17 offset:512
    v_mfma_f32_16x16x32_bf16 v[68:71], v[56:59], v[44:47], v[68:71]
    ds_read_b128 v[28:31], v12
    ds_read_b128 v[32:35], v12 offset:2048
    v_mfma_f32_16x16x32_bf16 v[72:75], v[56:59], v[48:51], v[72:75]
    s_waitcnt lgkmcnt(0)
    v_mfma_f32_16x16x32_bf16 v[60:63], v[36:39], v[28:31], v[60:63]
    ds_read_b64_tr_b16 v[52:53], v16 offset:4096
    ds_read_b64_tr_b16 v[54:55], v16 offset:4608
    v_mfma_f32_16x16x32_bf16 v[64:67], v[36:39], v[32:35], v[64:67]
    ds_read_b64_tr_b16 v[56:57], v17 offset:4096
    ds_read_b64_tr_b16 v[58:59], v17 offset:4608
    v_mfma_f32_16x16x32_bf16 v[68:71], v[40:43], v[28:31], v[68:71]
    ds_read_b128 v[44:47], v13
    ds_read_b128 v[48:51], v13 offset:2048
    v_mfma_f32_16x16x32_bf16 v[72:75], v[40:43], v[32:35], v[72:75]
    s_waitcnt lgkmcnt(0)
    s_barrier
    v_mfma_f32_16x16x32_bf16 v[60:63], v[52:55], v[44:47], v[60:63]
    ds_read_b64_tr_b16 v[36:37], v16 offset:16384
    ds_read_b64_tr_b16 v[38:39], v16 offset:16896
    v_mfma_f32_16x16x32_bf16 v[64:67], v[52:55], v[48:51], v[64:67]
    ds_read_b64_tr_b16 v[40:41], v17 offset:16384
    ds_read_b64_tr_b16 v[42:43], v17 offset:16896
    v_mfma_f32_16x16x32_bf16 v[68:71], v[56:59], v[44:47], v[68:71]
    ds_read_b128 v[28:31], v12 offset:16384
    ds_read_b128 v[32:35], v12 offset:18432
    v_mfma_f32_16x16x32_bf16 v[72:75], v[56:59], v[48:51], v[72:75]
    s_waitcnt lgkmcnt(0)
    v_mfma_f32_16x16x32_bf16 v[60:63], v[36:39], v[28:31], v[60:63]
    ds_read_b64_tr_b16 v[52:53], v16 offset:20480
    ds_read_b64_tr_b16 v[54:55], v16 offset:20992
    v_mfma_f32_16x16x32_bf16 v[64:67], v[36:39], v[32:35], v[64:67]
    ds_read_b64_tr_b16 v[56:57], v17 offset:20480
    ds_read_b64_tr_b16 v[58:59], v17 offset:20992
    v_mfma_f32_16x16x32_bf16 v[68:71], v[40:43], v[28:31], v[68:71]
    ds_read_b128 v[44:47], v13 offset:16384
    ds_read_b128 v[48:51], v13 offset:18432
    v_mfma_f32_16x16x32_bf16 v[72:75], v[40:43], v[32:35], v[72:75]
    s_waitcnt lgkmcnt(0)
    s_barrier
    v_mfma_f32_16x16x32_bf16 v[60:63], v[52:55], v[44:47], v[60:63]
    ds_read_b64_tr_b16 v[36:37], v16 offset:32768
    ds_read_b64_tr_b16 v[38:39], v16 offset:33280
    v_mfma_f32_16x16x32_bf16 v[64:67], v[52:55], v[48:51], v[64:67]
    ds_read_b64_tr_b16 v[40:41], v17 offset:32768
    ds_read_b64_tr_b16 v[42:43], v17 offset:33280
    v_mfma_f32_16x16x32_bf16 v[68:71], v[56:59], v[44:47], v[68:71]
    ds_read_b128 v[28:31], v12 offset:32768
    ds_read_b128 v[32:35], v12 offset:34816
    v_mfma_f32_16x16x32_bf16 v[72:75], v[56:59], v[48:51], v[72:75]
    s_waitcnt lgkmcnt(0)
    v_mfma_f32_16x16x32_bf16 v[60:63], v[36:39], v[28:31], v[60:63]
    ds_read_b64_tr_b16 v[52:53], v16 offset:36864
    ds_read_b64_tr_b16 v[54:55], v16 offset:37376
    v_mfma_f32_16x16x32_bf16 v[64:67], v[36:39], v[32:35], v[64:67]
    ds_read_b64_tr_b16 v[56:57], v17 offset:36864
    ds_read_b64_tr_b16 v[58:59], v17 offset:37376
    v_mfma_f32_16x16x32_bf16 v[68:71], v[40:43], v[28:31], v[68:71]
    ds_read_b128 v[44:47], v13 offset:32768
    ds_read_b128 v[48:51], v13 offset:34816
    v_mfma_f32_16x16x32_bf16 v[72:75], v[40:43], v[32:35], v[72:75]
    s_waitcnt lgkmcnt(0)
    s_barrier
    v_mfma_f32_16x16x32_bf16 v[60:63], v[52:55], v[44:47], v[60:63]
    ds_read_b64_tr_b16 v[36:37], v16 offset:49152
    ds_read_b64_tr_b16 v[38:39], v16 offset:49664
    v_mfma_f32_16x16x32_bf16 v[64:67], v[52:55], v[48:51], v[64:67]
    ds_read_b64_tr_b16 v[40:41], v17 offset:49152
    ds_read_b64_tr_b16 v[42:43], v17 offset:49664
    v_mfma_f32_16x16x32_bf16 v[68:71], v[56:59], v[44:47], v[68:71]
    ds_read_b128 v[28:31], v12 offset:49152
    ds_read_b128 v[32:35], v12 offset:51200
    v_mfma_f32_16x16x32_bf16 v[72:75], v[56:59], v[48:51], v[72:75]
    s_waitcnt lgkmcnt(0)
    v_mfma_f32_16x16x32_bf16 v[60:63], v[36:39], v[28:31], v[60:63]
    ds_read_b64_tr_b16 v[52:53], v16 offset:53248
    ds_read_b64_tr_b16 v[54:55], v16 offset:53760
    v_mfma_f32_16x16x32_bf16 v[64:67], v[36:39], v[32:35], v[64:67]
    ds_read_b64_tr_b16 v[56:57], v17 offset:53248
    ds_read_b64_tr_b16 v[58:59], v17 offset:53760
    v_mfma_f32_16x16x32_bf16 v[68:71], v[40:43], v[28:31], v[68:71]
    ds_read_b128 v[44:47], v13 offset:49152
    ds_read_b128 v[48:51], v13 offset:51200
    v_mfma_f32_16x16x32_bf16 v[72:75], v[40:43], v[32:35], v[72:75]
    s_waitcnt lgkmcnt(0)
    v_mfma_f32_16x16x32_bf16 v[60:63], v[52:55], v[44:47], v[60:63]
    v_mfma_f32_16x16x32_bf16 v[64:67], v[52:55], v[48:51], v[64:67]
    v_mfma_f32_16x16x32_bf16 v[68:71], v[56:59], v[44:47], v[68:71]
    v_mfma_f32_16x16x32_bf16 v[72:75], v[56:59], v[48:51], v[72:75]
    s_waitcnt vmcnt(0)
    s_nop 3
    v_cvt_pk_bf16_f32 v80, v60, v61
    v_lshlrev_b32 v60, 16, v80
    v_and_b32 v61, 4294901760, v80
    v_cvt_pk_bf16_f32 v81, v62, v63
    v_lshlrev_b32 v62, 16, v81
    v_and_b32 v63, 4294901760, v81
    v_lshlrev_b32 v76, 16, v20
    v_and_b32 v77, 4294901760, v20
    v_lshlrev_b32 v78, 16, v21
    v_and_b32 v79, 4294901760, v21
    v_pk_add_f32 v[60:61], v[60:61], v[76:77]
    v_pk_add_f32 v[62:63], v[62:63], v[78:79]
    v_cvt_pk_bf16_f32 v20, v60, v61
    v_cvt_pk_bf16_f32 v21, v62, v63
    buffer_store_dwordx2 v[20:21], v8, s[52:55], 0 offen
    v_cvt_pk_bf16_f32 v80, v64, v65
    v_lshlrev_b32 v64, 16, v80
    v_and_b32 v65, 4294901760, v80
    v_cvt_pk_bf16_f32 v81, v66, v67
    v_lshlrev_b32 v66, 16, v81
    v_and_b32 v67, 4294901760, v81
    v_lshlrev_b32 v76, 16, v22
    v_and_b32 v77, 4294901760, v22
    v_lshlrev_b32 v78, 16, v23
    v_and_b32 v79, 4294901760, v23
    v_pk_add_f32 v[64:65], v[64:65], v[76:77]
    v_pk_add_f32 v[66:67], v[66:67], v[78:79]
    v_cvt_pk_bf16_f32 v22, v64, v65
    v_cvt_pk_bf16_f32 v23, v66, v67
    buffer_store_dwordx2 v[22:23], v8, s[52:55], s62 offen
    v_cvt_pk_bf16_f32 v80, v68, v69
    v_lshlrev_b32 v68, 16, v80
    v_and_b32 v69, 4294901760, v80
    v_cvt_pk_bf16_f32 v81, v70, v71
    v_lshlrev_b32 v70, 16, v81
    v_and_b32 v71, 4294901760, v81
    v_lshlrev_b32 v76, 16, v24
    v_and_b32 v77, 4294901760, v24
    v_lshlrev_b32 v78, 16, v25
    v_and_b32 v79, 4294901760, v25
    v_pk_add_f32 v[68:69], v[68:69], v[76:77]
    v_pk_add_f32 v[70:71], v[70:71], v[78:79]
    v_cvt_pk_bf16_f32 v24, v68, v69
    v_cvt_pk_bf16_f32 v25, v70, v71
    buffer_store_dwordx2 v[24:25], v8, s[52:55], 0 offen offset:32
    v_cvt_pk_bf16_f32 v80, v72, v73
    v_lshlrev_b32 v72, 16, v80
    v_and_b32 v73, 4294901760, v80
    v_cvt_pk_bf16_f32 v81, v74, v75
    v_lshlrev_b32 v74, 16, v81
    v_and_b32 v75, 4294901760, v81
    v_lshlrev_b32 v76, 16, v26
    v_and_b32 v77, 4294901760, v26
    v_lshlrev_b32 v78, 16, v27
    v_and_b32 v79, 4294901760, v27
    v_pk_add_f32 v[72:73], v[72:73], v[76:77]
    v_pk_add_f32 v[74:75], v[74:75], v[78:79]
    v_cvt_pk_bf16_f32 v26, v72, v73
    v_cvt_pk_bf16_f32 v27, v74, v75
    buffer_store_dwordx2 v[26:27], v8, s[52:55], s62 offen offset:32
    s_endpgm
L_sequential_preLN__sliding_local_dilated__mixer_channel_mlp__prompt_k2_kernel_loader:
    s_sub_u32 s58, s3, 4
    v_lshrrev_b32 v3, 3, v1
    v_and_b32 v4, 7, v1
    v_xor_b32 v5, v4, v3
    v_lshlrev_b32 v5, 4, v5
    s_lshl_b32 s63, s56, 6
    s_lshl_b32 s64, s58, 4
    s_add_u32 s63, s63, s64
    v_add_u32 v6, s63, v3
    s_mov_b32 s66, 1024
    v_mul_lo_u32 v6, v6, s66
    v_add_u32 v7, v6, v5
    s_lshl_b32 s65, s58, 11
    v_and_b32 v6, 2, v3
    v_xor_b32 v6, v6, v4
    v_lshlrev_b32 v6, 4, v6
    s_lshl_b32 s63, s58, 4
    s_add_u32 s63, s63, 0
    v_add_u32 v8, s63, v3
    v_lshl_add_u32 v8, v8, 10, v6
    s_lshl_b32 s63, s57, 7
    v_add_u32 v8, s63, v8
    v_and_b32 v6, 2, v3
    v_or_b32 v6, 4, v6
    v_xor_b32 v6, v6, v4
    v_lshlrev_b32 v6, 4, v6
    s_lshl_b32 s63, s58, 4
    s_add_u32 s63, s63, 8
    v_add_u32 v9, s63, v3
    v_lshl_add_u32 v9, v9, 10, v6
    s_lshl_b32 s63, s57, 7
    v_add_u32 v9, s63, v9
    s_waitcnt lgkmcnt(0)
    s_mov_b32 s36, s34
    s_and_b32 s37, s35, 65535
    s_mov_b32 s38, 2097152
    s_mov_b32 s39, 131072
    s_mov_b32 s40, s20
    s_and_b32 s41, s21, 65535
    s_mov_b32 s42, 524288
    s_mov_b32 s43, 131072
    s_mov_b32 s44, s16
    s_and_b32 s45, s17, 65535
    s_mov_b32 s46, 2097152
    s_mov_b32 s47, 131072
    s_add_u32 s52, s34, 2097152
    s_addc_u32 s53, s35, 0
    s_and_b32 s53, s53, 65535
    s_mov_b32 s54, 2097152
    s_mov_b32 s55, 131072
    s_and_b32 s68, s2, 7
    s_mul_i32 s68, s68, 8
    s_lshr_b32 s68, s68, 3
    s_add_u32 m0, s65, 8192
    s_lshl_b32 s67, s68, 16
    buffer_load_dwordx4 v8, s[40:43], s67 offen lds
    s_add_u32 m0, s65, 9216
    s_lshl_b32 s67, s68, 16
    buffer_load_dwordx4 v9, s[40:43], s67 offen lds
    s_add_u32 m0, s65, 0
    s_lshl_b32 s67, s68, 7
    buffer_load_dwordx4 v7, s[36:39], s67 offen lds
    s_add_u32 m0, s65, 1024
    s_lshl_b32 s67, s68, 7
    s_add_u32 s67, s67, 8192
    buffer_load_dwordx4 v7, s[36:39], s67 offen lds
    s_add_u32 s68, s68, 1
    s_cmp_ge_u32 s68, 8
    s_cselect_b32 s68, 0, s68
    s_add_u32 m0, s65, 24576
    s_lshl_b32 s67, s68, 16
    buffer_load_dwordx4 v8, s[40:43], s67 offen lds
    s_add_u32 m0, s65, 25600
    s_lshl_b32 s67, s68, 16
    buffer_load_dwordx4 v9, s[40:43], s67 offen lds
    s_add_u32 m0, s65, 16384
    s_lshl_b32 s67, s68, 7
    buffer_load_dwordx4 v7, s[36:39], s67 offen lds
    s_add_u32 m0, s65, 17408
    s_lshl_b32 s67, s68, 7
    s_add_u32 s67, s67, 8192
    buffer_load_dwordx4 v7, s[36:39], s67 offen lds
    s_add_u32 s68, s68, 1
    s_cmp_ge_u32 s68, 8
    s_cselect_b32 s68, 0, s68
    s_waitcnt vmcnt(4)
    s_barrier
    s_add_u32 m0, s65, 40960
    s_lshl_b32 s67, s68, 16
    buffer_load_dwordx4 v8, s[40:43], s67 offen lds
    s_add_u32 m0, s65, 41984
    s_lshl_b32 s67, s68, 16
    buffer_load_dwordx4 v9, s[40:43], s67 offen lds
    s_add_u32 m0, s65, 32768
    s_lshl_b32 s67, s68, 7
    buffer_load_dwordx4 v7, s[36:39], s67 offen lds
    s_add_u32 m0, s65, 33792
    s_lshl_b32 s67, s68, 7
    s_add_u32 s67, s67, 8192
    buffer_load_dwordx4 v7, s[36:39], s67 offen lds
    s_add_u32 s68, s68, 1
    s_cmp_ge_u32 s68, 8
    s_cselect_b32 s68, 0, s68
    s_add_u32 m0, s65, 57344
    s_lshl_b32 s67, s68, 16
    buffer_load_dwordx4 v8, s[40:43], s67 offen lds
    s_add_u32 m0, s65, 58368
    s_lshl_b32 s67, s68, 16
    buffer_load_dwordx4 v9, s[40:43], s67 offen lds
    s_add_u32 m0, s65, 49152
    s_lshl_b32 s67, s68, 7
    buffer_load_dwordx4 v7, s[36:39], s67 offen lds
    s_add_u32 m0, s65, 50176
    s_lshl_b32 s67, s68, 7
    s_add_u32 s67, s67, 8192
    buffer_load_dwordx4 v7, s[36:39], s67 offen lds
    s_add_u32 s68, s68, 1
    s_cmp_ge_u32 s68, 8
    s_cselect_b32 s68, 0, s68
    s_waitcnt vmcnt(8)
    s_barrier
    s_add_u32 m0, s65, 73728
    s_lshl_b32 s67, s68, 16
    buffer_load_dwordx4 v8, s[40:43], s67 offen lds
    s_add_u32 m0, s65, 74752
    s_lshl_b32 s67, s68, 16
    buffer_load_dwordx4 v9, s[40:43], s67 offen lds
    s_add_u32 m0, s65, 65536
    s_lshl_b32 s67, s68, 7
    buffer_load_dwordx4 v7, s[36:39], s67 offen lds
    s_add_u32 m0, s65, 66560
    s_lshl_b32 s67, s68, 7
    s_add_u32 s67, s67, 8192
    buffer_load_dwordx4 v7, s[36:39], s67 offen lds
    s_add_u32 s68, s68, 1
    s_cmp_ge_u32 s68, 8
    s_cselect_b32 s68, 0, s68
    s_add_u32 m0, s65, 90112
    s_lshl_b32 s67, s68, 16
    buffer_load_dwordx4 v8, s[40:43], s67 offen lds
    s_add_u32 m0, s65, 91136
    s_lshl_b32 s67, s68, 16
    buffer_load_dwordx4 v9, s[40:43], s67 offen lds
    s_add_u32 m0, s65, 81920
    s_lshl_b32 s67, s68, 7
    buffer_load_dwordx4 v7, s[36:39], s67 offen lds
    s_add_u32 m0, s65, 82944
    s_lshl_b32 s67, s68, 7
    s_add_u32 s67, s67, 8192
    buffer_load_dwordx4 v7, s[36:39], s67 offen lds
    s_add_u32 s68, s68, 1
    s_cmp_ge_u32 s68, 8
    s_cselect_b32 s68, 0, s68
    s_waitcnt vmcnt(12)
    s_barrier
    s_add_u32 m0, s65, 106496
    s_lshl_b32 s67, s68, 16
    buffer_load_dwordx4 v8, s[40:43], s67 offen lds
    s_add_u32 m0, s65, 107520
    s_lshl_b32 s67, s68, 16
    buffer_load_dwordx4 v9, s[40:43], s67 offen lds
    s_add_u32 m0, s65, 98304
    s_lshl_b32 s67, s68, 7
    buffer_load_dwordx4 v7, s[36:39], s67 offen lds
    s_add_u32 m0, s65, 99328
    s_lshl_b32 s67, s68, 7
    s_add_u32 s67, s67, 8192
    buffer_load_dwordx4 v7, s[36:39], s67 offen lds
    s_add_u32 s68, s68, 1
    s_cmp_ge_u32 s68, 8
    s_cselect_b32 s68, 0, s68
    s_add_u32 m0, s65, 122880
    s_lshl_b32 s67, s68, 16
    buffer_load_dwordx4 v8, s[40:43], s67 offen lds
    s_add_u32 m0, s65, 123904
    s_lshl_b32 s67, s68, 16
    buffer_load_dwordx4 v9, s[40:43], s67 offen lds
    s_add_u32 m0, s65, 114688
    s_lshl_b32 s67, s68, 7
    buffer_load_dwordx4 v7, s[36:39], s67 offen lds
    s_add_u32 m0, s65, 115712
    s_lshl_b32 s67, s68, 7
    s_add_u32 s67, s67, 8192
    buffer_load_dwordx4 v7, s[36:39], s67 offen lds
    s_add_u32 s68, s68, 1
    s_cmp_ge_u32 s68, 8
    s_cselect_b32 s68, 0, s68
    s_waitcnt vmcnt(16)
    s_barrier
    s_waitcnt vmcnt(12)
    s_barrier
    s_waitcnt vmcnt(8)
    s_barrier
    s_waitcnt vmcnt(4)
    s_barrier
    s_waitcnt vmcnt(0)
    s_barrier
L_sequential_preLN__sliding_local_dilated__mixer_channel_mlp__prompt_k2_kernel_end:
    s_endpgm
.section .rodata,"a"
.p2align 6
.amdhsa_kernel sequential_preLN__sliding_local_dilated__mixer_channel_mlp__prompt_k2_kernel
  .amdhsa_next_free_vgpr 82
  .amdhsa_next_free_sgpr 69
  .amdhsa_accum_offset 84
  .amdhsa_group_segment_fixed_size 0
  .amdhsa_kernarg_size 88
  .amdhsa_user_sgpr_count 2
  .amdhsa_user_sgpr_kernarg_segment_ptr 1
  .amdhsa_system_sgpr_workgroup_id_x 1
.end_amdhsa_kernel
.text
.globl sequential_preLN__sliding_local_dilated__mixer_channel_mlp__prompt_k3_kernel
.p2align 8
.type sequential_preLN__sliding_local_dilated__mixer_channel_mlp__prompt_k3_kernel,@function
sequential_preLN__sliding_local_dilated__mixer_channel_mlp__prompt_k3_kernel:
    s_cmp_ge_u32 s2, 256
    s_nop 0
    s_cbranch_scc1 L_sequential_preLN__sliding_local_dilated__mixer_channel_mlp__prompt_k3_kernel_end
    s_load_dwordx16 s[16:31], s[0:1], 0
    s_load_dwordx2 s[32:33], s[0:1], 64
    s_load_dwordx2 s[34:35], s[0:1], 80
    v_lshrrev_b32 v2, 6, v0
    v_and_b32 v1, 63, v0
    v_readfirstlane_b32 s3, v2
    s_and_b32 s58, s2, 7
    s_lshr_b32 s56, s58, 1
    s_lshl_b32 s56, s56, 2
    s_lshr_b32 s59, s2, 3
    s_and_b32 s60, s59, 3
    s_add_u32 s56, s56, s60
    s_and_b32 s57, s58, 1
    s_lshl_b32 s57, s57, 3
    s_lshr_b32 s59, s59, 2
    s_add_u32 s57, s57, s59
    v_and_b32 v3, 15, v1
    v_lshrrev_b32 v4, 4, v1
    v_and_b32 v7, 7, v1
    s_and_b32 s61, s3, 3
    s_mul_i32 s58, s57, 224
    v_lshl_add_u32 v8, v4, 3, s58
    s_lshl_b32 s59, s56, 7
    s_lshl_b32 s60, s61, 5
    s_add_u32 s59, s59, s60
    v_add_u32 v9, s59, v3
    s_mov_b32 s60, 3584
    v_mul_lo_u32 v9, v9, s60
    v_add_u32 v9, v9, v8
    v_lshlrev_b32 v10, 4, v4
    v_add_u32 v10, 131072, v10
    s_lshl_b32 s58, s61, 13
    v_lshl_add_u32 v11, v1, 4, s58
    s_cmp_ge_u32 s3, 4
    s_nop 3
    s_cbranch_scc1 L_sequential_preLN__sliding_local_dilated__mixer_channel_mlp__prompt_k3_kernel_loader
    v_add_u32 v5, 0, v4
    v_xor_b32 v5, v5, v7
    v_lshlrev_b32 v5, 4, v5
    v_lshl_add_u32 v5, v3, 7, v5
    s_lshl_b32 s58, s3, 12
    v_add_u32 v26, s58, v5
    v_add_u32 v28, 65536, v26
    v_add_u32 v5, 4, v4
    v_xor_b32 v5, v5, v7
    v_lshlrev_b32 v5, 4, v5
    v_lshl_add_u32 v5, v3, 7, v5
    s_lshl_b32 s58, s3, 12
    v_add_u32 v27, s58, v5
    v_add_u32 v29, 65536, v27
    v_lshrrev_b32 v30, 2, v3
    v_and_b32 v31, 3, v3
    v_and_b32 v32, 1, v4
    v_lshlrev_b32 v32, 3, v32
    v_lshl_add_u32 v32, v30, 1, v32
    v_lshl_add_u32 v33, v4, 3, v30
    v_lshlrev_b32 v33, 8, v33
    v_and_b32 v5, 1, v31
    v_lshl_add_u32 v33, v5, 3, v33
    v_add_u32 v33, 16384, v33
    s_lshl_b32 s59, s3, 1
    s_add_u32 s60, s3, 4
    s_min_u32 s60, s60, 6
    s_lshl_b32 s60, s60, 1
    v_lshrrev_b32 v5, 1, v31
    v_add_u32 v5, 0, v5
    v_xor_b32 v5, v5, v32
    v_lshl_add_u32 v34, v5, 4, v33
    v_add_u32 v43, 65536, v34
    v_lshrrev_b32 v5, 1, v31
    v_add_u32 v5, 2, v5
    v_xor_b32 v5, v5, v32
    v_lshl_add_u32 v35, v5, 4, v33
    v_add_u32 v44, 65536, v35
    v_lshrrev_b32 v5, 1, v31
    v_add_u32 v5, 4, v5
    v_xor_b32 v5, v5, v32
    v_lshl_add_u32 v36, v5, 4, v33
    v_add_u32 v45, 65536, v36
    v_lshrrev_b32 v5, 1, v31
    v_add_u32 v5, 6, v5
    v_xor_b32 v5, v5, v32
    v_lshl_add_u32 v37, v5, 4, v33
    v_add_u32 v46, 65536, v37
    v_lshrrev_b32 v5, 1, v31
    v_add_u32 v5, 8, v5
    v_xor_b32 v5, v5, v32
    v_lshl_add_u32 v38, v5, 4, v33
    v_add_u32 v47, 65536, v38
    v_lshrrev_b32 v5, 1, v31
    v_add_u32 v5, 10, v5
    v_xor_b32 v5, v5, v32
    v_lshl_add_u32 v39, v5, 4, v33
    v_add_u32 v48, 65536, v39
    v_lshrrev_b32 v5, 1, v31
    v_add_u32 v5, 12, v5
    v_xor_b32 v5, v5, v32
    v_lshl_add_u32 v40, v5, 4, v33
    v_add_u32 v49, 65536, v40
    v_lshrrev_b32 v5, 1, v31
    v_add_u32 v5, s59, v5
    v_xor_b32 v5, v5, v32
    v_lshl_add_u32 v41, v5, 4, v33
    v_add_u32 v50, 65536, v41
    v_lshrrev_b32 v5, 1, v31
    v_add_u32 v5, s60, v5
    v_xor_b32 v5, v5, v32
    v_lshl_add_u32 v42, v5, 4, v33
    v_add_u32 v51, 65536, v42
    v_mov_b32 v52, 1065369472
    v_mov_b32 v53, 1065369472
    v_mov_b32 v54, 1065369472
    v_mov_b32 v55, 1065369472
    s_lshl_b32 s62, s59, 5
    v_add_u32 v56, s62, v10
    s_lshl_b32 s62, s60, 5
    v_add_u32 v57, s62, v10
    v_and_b32 v5, 3, v1
    v_cmp_eq_u32 s[62:63], 1, v5
    v_cmp_eq_u32 s[64:65], 2, v5
    v_cmp_eq_u32 s[66:67], 3, v5
    v_cmp_eq_u32 s[68:69], 0, v3
    v_lshrrev_b32 v5, 2, v3
    v_lshl_add_u32 v5, v5, 4, v3
    v_lshlrev_b32 v58, 2, v5
    s_waitcnt lgkmcnt(0)
    s_add_u32 s36, s34, 2097152
    s_addc_u32 s37, s35, 0
    s_and_b32 s37, s37, 65535
    s_mov_b32 s38, 2097152
    s_mov_b32 s39, 131072
    s_mov_b32 s40, s24
    s_and_b32 s41, s25, 65535
    s_mov_b32 s42, 1835008
    s_mov_b32 s43, 131072
    s_mov_b32 s44, s26
    s_and_b32 s45, s27, 65535
    s_mov_b32 s46, 3584
    s_mov_b32 s47, 131072
    s_add_u32 s52, s34, 4194304
    s_addc_u32 s53, s35, 0
    s_and_b32 s53, s53, 65535
    s_mov_b32 s54, 7340032
    s_mov_b32 s55, 131072
    buffer_load_dwordx2 v[12:13], v8, s[44:47], 0 offen
    buffer_load_dwordx2 v[14:15], v8, s[44:47], 0 offen offset:32
    buffer_load_dwordx2 v[16:17], v8, s[44:47], 0 offen offset:64
    buffer_load_dwordx2 v[18:19], v8, s[44:47], 0 offen offset:96
    buffer_load_dwordx2 v[20:21], v8, s[44:47], 0 offen offset:128
    buffer_load_dwordx2 v[22:23], v8, s[44:47], 0 offen offset:160
    buffer_load_dwordx2 v[24:25], v8, s[44:47], 0 offen offset:192
    s_barrier
    ds_read_b128 v[60:63], v26
    ds_read_b128 v[64:67], v26 offset:2048
    ds_read_b64_tr_b16 v[68:69], v34
    ds_read_b64_tr_b16 v[70:71], v34 offset:1024
    ds_read_b64_tr_b16 v[72:73], v35
    ds_read_b64_tr_b16 v[74:75], v35 offset:1024
    ds_read_b64_tr_b16 v[76:77], v36
    ds_read_b64_tr_b16 v[78:79], v36 offset:1024
    ds_read_b64_tr_b16 v[80:81], v37
    ds_read_b64_tr_b16 v[82:83], v37 offset:1024
    ds_read_b64_tr_b16 v[84:85], v38
    ds_read_b64_tr_b16 v[86:87], v38 offset:1024
    ds_read_b64_tr_b16 v[88:89], v39
    ds_read_b64_tr_b16 v[90:91], v39 offset:1024
    ds_read_b64_tr_b16 v[92:93], v40
    ds_read_b64_tr_b16 v[94:95], v40 offset:1024
    ds_read_b64_tr_b16 v[96:97], v41
    ds_read_b64_tr_b16 v[98:99], v41 offset:1024
    ds_read_b64_tr_b16 v[100:101], v42
    ds_read_b64_tr_b16 v[102:103], v42 offset:1024
    s_waitcnt lgkmcnt(0)
    v_mfma_f32_16x16x32_bf16 v[212:215], v[52:55], v[60:63], 0
    ds_read_b128 v[104:107], v27
    ds_read_b128 v[108:111], v27 offset:2048
    v_mfma_f32_16x16x32_bf16 v[220:223], v[60:63], v[60:63], 0
    ds_read_b64_tr_b16 v[112:113], v34 offset:8192
    ds_read_b64_tr_b16 v[114:115], v34 offset:9216
    v_mfma_f32_16x16x32_bf16 v[216:219], v[52:55], v[64:67], 0
    ds_read_b64_tr_b16 v[116:117], v35 offset:8192
    ds_read_b64_tr_b16 v[118:119], v35 offset:9216
    v_mfma_f32_16x16x32_bf16 v[224:227], v[64:67], v[64:67], 0
    ds_read_b64_tr_b16 v[120:121], v36 offset:8192
    ds_read_b64_tr_b16 v[122:123], v36 offset:9216
    v_mfma_f32_16x16x32_bf16 v[148:151], v[68:71], v[60:63], 0
    ds_read_b64_tr_b16 v[124:125], v37 offset:8192
    ds_read_b64_tr_b16 v[126:127], v37 offset:9216
    v_mfma_f32_16x16x32_bf16 v[152:155], v[68:71], v[64:67], 0
    ds_read_b64_tr_b16 v[128:129], v38 offset:8192
    ds_read_b64_tr_b16 v[130:131], v38 offset:9216
    v_mfma_f32_16x16x32_bf16 v[156:159], v[72:75], v[60:63], 0
    ds_read_b64_tr_b16 v[132:133], v39 offset:8192
    ds_read_b64_tr_b16 v[134:135], v39 offset:9216
    v_mfma_f32_16x16x32_bf16 v[160:163], v[72:75], v[64:67], 0
    ds_read_b64_tr_b16 v[136:137], v40 offset:8192
    ds_read_b64_tr_b16 v[138:139], v40 offset:9216
    v_mfma_f32_16x16x32_bf16 v[164:167], v[76:79], v[60:63], 0
    ds_read_b64_tr_b16 v[140:141], v41 offset:8192
    ds_read_b64_tr_b16 v[142:143], v41 offset:9216
    v_mfma_f32_16x16x32_bf16 v[168:171], v[76:79], v[64:67], 0
    ds_read_b64_tr_b16 v[144:145], v42 offset:8192
    ds_read_b64_tr_b16 v[146:147], v42 offset:9216
    v_mfma_f32_16x16x32_bf16 v[172:175], v[80:83], v[60:63], 0
    v_mfma_f32_16x16x32_bf16 v[176:179], v[80:83], v[64:67], 0
    v_mfma_f32_16x16x32_bf16 v[180:183], v[84:87], v[60:63], 0
    v_mfma_f32_16x16x32_bf16 v[184:187], v[84:87], v[64:67], 0
    v_mfma_f32_16x16x32_bf16 v[188:191], v[88:91], v[60:63], 0
    v_mfma_f32_16x16x32_bf16 v[192:195], v[88:91], v[64:67], 0
    v_mfma_f32_16x16x32_bf16 v[196:199], v[92:95], v[60:63], 0
    v_mfma_f32_16x16x32_bf16 v[200:203], v[92:95], v[64:67], 0
    v_mfma_f32_16x16x32_bf16 v[204:207], v[96:99], v[52:55], 0
    v_mfma_f32_16x16x32_bf16 v[208:211], v[100:103], v[52:55], 0
    s_waitcnt lgkmcnt(0)
    s_barrier
    v_mfma_f32_16x16x32_bf16 v[212:215], v[52:55], v[104:107], v[212:215]
    ds_read_b128 v[60:63], v26 offset:32768
    ds_read_b128 v[64:67], v26 offset:34816
    v_mfma_f32_16x16x32_bf16 v[220:223], v[104:107], v[104:107], v[220:223]
    ds_read_b64_tr_b16 v[68:69], v34 offset:32768
    ds_read_b64_tr_b16 v[70:71], v34 offset:33792
    v_mfma_f32_16x16x32_bf16 v[216:219], v[52:55], v[108:111], v[216:219]
    ds_read_b64_tr_b16 v[72:73], v35 offset:32768
    ds_read_b64_tr_b16 v[74:75], v35 offset:33792
    v_mfma_f32_16x16x32_bf16 v[224:227], v[108:111], v[108:111], v[224:227]
    ds_read_b64_tr_b16 v[76:77], v36 offset:32768
    ds_read_b64_tr_b16 v[78:79], v36 offset:33792
    v_mfma_f32_16x16x32_bf16 v[148:151], v[112:115], v[104:107], v[148:151]
    ds_read_b64_tr_b16 v[80:81], v37 offset:32768
    ds_read_b64_tr_b16 v[82:83], v37 offset:33792
    v_mfma_f32_16x16x32_bf16 v[152:155], v[112:115], v[108:111], v[152:155]
    ds_read_b64_tr_b16 v[84:85], v38 offset:32768
    ds_read_b64_tr_b16 v[86:87], v38 offset:33792
    v_mfma_f32_16x16x32_bf16 v[156:159], v[116:119], v[104:107], v[156:159]
    ds_read_b64_tr_b16 v[88:89], v39 offset:32768
    ds_read_b64_tr_b16 v[90:91], v39 offset:33792
    v_mfma_f32_16x16x32_bf16 v[160:163], v[116:119], v[108:111], v[160:163]
    ds_read_b64_tr_b16 v[92:93], v40 offset:32768
    ds_read_b64_tr_b16 v[94:95], v40 offset:33792
    v_mfma_f32_16x16x32_bf16 v[164:167], v[120:123], v[104:107], v[164:167]
    ds_read_b64_tr_b16 v[96:97], v41 offset:32768
    ds_read_b64_tr_b16 v[98:99], v41 offset:33792
    v_mfma_f32_16x16x32_bf16 v[168:171], v[120:123], v[108:111], v[168:171]
    ds_read_b64_tr_b16 v[100:101], v42 offset:32768
    ds_read_b64_tr_b16 v[102:103], v42 offset:33792
    v_mfma_f32_16x16x32_bf16 v[172:175], v[124:127], v[104:107], v[172:175]
    v_mfma_f32_16x16x32_bf16 v[176:179], v[124:127], v[108:111], v[176:179]
    v_mfma_f32_16x16x32_bf16 v[180:183], v[128:131], v[104:107], v[180:183]
    v_mfma_f32_16x16x32_bf16 v[184:187], v[128:131], v[108:111], v[184:187]
    v_mfma_f32_16x16x32_bf16 v[188:191], v[132:135], v[104:107], v[188:191]
    v_mfma_f32_16x16x32_bf16 v[192:195], v[132:135], v[108:111], v[192:195]
    v_mfma_f32_16x16x32_bf16 v[196:199], v[136:139], v[104:107], v[196:199]
    v_mfma_f32_16x16x32_bf16 v[200:203], v[136:139], v[108:111], v[200:203]
    v_mfma_f32_16x16x32_bf16 v[204:207], v[140:143], v[52:55], v[204:207]
    v_mfma_f32_16x16x32_bf16 v[208:211], v[144:147], v[52:55], v[208:211]
    s_waitcnt lgkmcnt(0)
    v_mfma_f32_16x16x32_bf16 v[212:215], v[52:55], v[60:63], v[212:215]
    ds_read_b128 v[104:107], v27 offset:32768
    ds_read_b128 v[108:111], v27 offset:34816
    v_mfma_f32_16x16x32_bf16 v[220:223], v[60:63], v[60:63], v[220:223]
    ds_read_b64_tr_b16 v[112:113], v34 offset:40960
    ds_read_b64_tr_b16 v[114:115], v34 offset:41984
    v_mfma_f32_16x16x32_bf16 v[216:219], v[52:55], v[64:67], v[216:219]
    ds_read_b64_tr_b16 v[116:117], v35 offset:40960
    ds_read_b64_tr_b16 v[118:119], v35 offset:41984
    v_mfma_f32_16x16x32_bf16 v[224:227], v[64:67], v[64:67], v[224:227]
    ds_read_b64_tr_b16 v[120:121], v36 offset:40960
    ds_read_b64_tr_b16 v[122:123], v36 offset:41984
    v_mfma_f32_16x16x32_bf16 v[148:151], v[68:71], v[60:63], v[148:151]
    ds_read_b64_tr_b16 v[124:125], v37 offset:40960
    ds_read_b64_tr_b16 v[126:127], v37 offset:41984
    v_mfma_f32_16x16x32_bf16 v[152:155], v[68:71], v[64:67], v[152:155]
    ds_read_b64_tr_b16 v[128:129], v38 offset:40960
    ds_read_b64_tr_b16 v[130:131], v38 offset:41984
    v_mfma_f32_16x16x32_bf16 v[156:159], v[72:75], v[60:63], v[156:159]
    ds_read_b64_tr_b16 v[132:133], v39 offset:40960
    ds_read_b64_tr_b16 v[134:135], v39 offset:41984
    v_mfma_f32_16x16x32_bf16 v[160:163], v[72:75], v[64:67], v[160:163]
    ds_read_b64_tr_b16 v[136:137], v40 offset:40960
    ds_read_b64_tr_b16 v[138:139], v40 offset:41984
    v_mfma_f32_16x16x32_bf16 v[164:167], v[76:79], v[60:63], v[164:167]
    ds_read_b64_tr_b16 v[140:141], v41 offset:40960
    ds_read_b64_tr_b16 v[142:143], v41 offset:41984
    v_mfma_f32_16x16x32_bf16 v[168:171], v[76:79], v[64:67], v[168:171]
    ds_read_b64_tr_b16 v[144:145], v42 offset:40960
    ds_read_b64_tr_b16 v[146:147], v42 offset:41984
    v_mfma_f32_16x16x32_bf16 v[172:175], v[80:83], v[60:63], v[172:175]
    v_mfma_f32_16x16x32_bf16 v[176:179], v[80:83], v[64:67], v[176:179]
    v_mfma_f32_16x16x32_bf16 v[180:183], v[84:87], v[60:63], v[180:183]
    v_mfma_f32_16x16x32_bf16 v[184:187], v[84:87], v[64:67], v[184:187]
    v_mfma_f32_16x16x32_bf16 v[188:191], v[88:91], v[60:63], v[188:191]
    v_mfma_f32_16x16x32_bf16 v[192:195], v[88:91], v[64:67], v[192:195]
    v_mfma_f32_16x16x32_bf16 v[196:199], v[92:95], v[60:63], v[196:199]
    v_mfma_f32_16x16x32_bf16 v[200:203], v[92:95], v[64:67], v[200:203]
    v_mfma_f32_16x16x32_bf16 v[204:207], v[96:99], v[52:55], v[204:207]
    v_mfma_f32_16x16x32_bf16 v[208:211], v[100:103], v[52:55], v[208:211]
    s_waitcnt lgkmcnt(0)
    s_barrier
    v_mfma_f32_16x16x32_bf16 v[212:215], v[52:55], v[104:107], v[212:215]
    ds_read_b128 v[60:63], v28
    ds_read_b128 v[64:67], v28 offset:2048
    v_mfma_f32_16x16x32_bf16 v[220:223], v[104:107], v[104:107], v[220:223]
    ds_read_b64_tr_b16 v[68:69], v43
    ds_read_b64_tr_b16 v[70:71], v43 offset:1024
    v_mfma_f32_16x16x32_bf16 v[216:219], v[52:55], v[108:111], v[216:219]
    ds_read_b64_tr_b16 v[72:73], v44
    ds_read_b64_tr_b16 v[74:75], v44 offset:1024
    v_mfma_f32_16x16x32_bf16 v[224:227], v[108:111], v[108:111], v[224:227]
    ds_read_b64_tr_b16 v[76:77], v45
    ds_read_b64_tr_b16 v[78:79], v45 offset:1024
    v_mfma_f32_16x16x32_bf16 v[148:151], v[112:115], v[104:107], v[148:151]
    ds_read_b64_tr_b16 v[80:81], v46
    ds_read_b64_tr_b16 v[82:83], v46 offset:1024
    v_mfma_f32_16x16x32_bf16 v[152:155], v[112:115], v[108:111], v[152:155]
    ds_read_b64_tr_b16 v[84:85], v47
    ds_read_b64_tr_b16 v[86:87], v47 offset:1024
    v_mfma_f32_16x16x32_bf16 v[156:159], v[116:119], v[104:107], v[156:159]
    ds_read_b64_tr_b16 v[88:89], v48
    ds_read_b64_tr_b16 v[90:91], v48 offset:1024
    v_mfma_f32_16x16x32_bf16 v[160:163], v[116:119], v[108:111], v[160:163]
    ds_read_b64_tr_b16 v[92:93], v49
    ds_read_b64_tr_b16 v[94:95], v49 offset:1024
    v_mfma_f32_16x16x32_bf16 v[164:167], v[120:123], v[104:107], v[164:167]
    ds_read_b64_tr_b16 v[96:97], v50
    ds_read_b64_tr_b16 v[98:99], v50 offset:1024
    v_mfma_f32_16x16x32_bf16 v[168:171], v[120:123], v[108:111], v[168:171]
    ds_read_b64_tr_b16 v[100:101], v51
    ds_read_b64_tr_b16 v[102:103], v51 offset:1024
    v_mfma_f32_16x16x32_bf16 v[172:175], v[124:127], v[104:107], v[172:175]
    v_mfma_f32_16x16x32_bf16 v[176:179], v[124:127], v[108:111], v[176:179]
    v_mfma_f32_16x16x32_bf16 v[180:183], v[128:131], v[104:107], v[180:183]
    v_mfma_f32_16x16x32_bf16 v[184:187], v[128:131], v[108:111], v[184:187]
    v_mfma_f32_16x16x32_bf16 v[188:191], v[132:135], v[104:107], v[188:191]
    v_mfma_f32_16x16x32_bf16 v[192:195], v[132:135], v[108:111], v[192:195]
    v_mfma_f32_16x16x32_bf16 v[196:199], v[136:139], v[104:107], v[196:199]
    v_mfma_f32_16x16x32_bf16 v[200:203], v[136:139], v[108:111], v[200:203]
    v_mfma_f32_16x16x32_bf16 v[204:207], v[140:143], v[52:55], v[204:207]
    v_mfma_f32_16x16x32_bf16 v[208:211], v[144:147], v[52:55], v[208:211]
    s_waitcnt lgkmcnt(0)
    v_mfma_f32_16x16x32_bf16 v[212:215], v[52:55], v[60:63], v[212:215]
    ds_read_b128 v[104:107], v29
    ds_read_b128 v[108:111], v29 offset:2048
    v_mfma_f32_16x16x32_bf16 v[220:223], v[60:63], v[60:63], v[220:223]
    ds_read_b64_tr_b16 v[112:113], v43 offset:8192
    ds_read_b64_tr_b16 v[114:115], v43 offset:9216
    v_mfma_f32_16x16x32_bf16 v[216:219], v[52:55], v[64:67], v[216:219]
    ds_read_b64_tr_b16 v[116:117], v44 offset:8192
    ds_read_b64_tr_b16 v[118:119], v44 offset:9216
    v_mfma_f32_16x16x32_bf16 v[224:227], v[64:67], v[64:67], v[224:227]
    ds_read_b64_tr_b16 v[120:121], v45 offset:8192
    ds_read_b64_tr_b16 v[122:123], v45 offset:9216
    v_mfma_f32_16x16x32_bf16 v[148:151], v[68:71], v[60:63], v[148:151]
    ds_read_b64_tr_b16 v[124:125], v46 offset:8192
    ds_read_b64_tr_b16 v[126:127], v46 offset:9216
    v_mfma_f32_16x16x32_bf16 v[152:155], v[68:71], v[64:67], v[152:155]
    ds_read_b64_tr_b16 v[128:129], v47 offset:8192
    ds_read_b64_tr_b16 v[130:131], v47 offset:9216
    v_mfma_f32_16x16x32_bf16 v[156:159], v[72:75], v[60:63], v[156:159]
    ds_read_b64_tr_b16 v[132:133], v48 offset:8192
    ds_read_b64_tr_b16 v[134:135], v48 offset:9216
    v_mfma_f32_16x16x32_bf16 v[160:163], v[72:75], v[64:67], v[160:163]
    ds_read_b64_tr_b16 v[136:137], v49 offset:8192
    ds_read_b64_tr_b16 v[138:139], v49 offset:9216
    v_mfma_f32_16x16x32_bf16 v[164:167], v[76:79], v[60:63], v[164:167]
    ds_read_b64_tr_b16 v[140:141], v50 offset:8192
    ds_read_b64_tr_b16 v[142:143], v50 offset:9216
    v_mfma_f32_16x16x32_bf16 v[168:171], v[76:79], v[64:67], v[168:171]
    ds_read_b64_tr_b16 v[144:145], v51 offset:8192
    ds_read_b64_tr_b16 v[146:147], v51 offset:9216
    v_mfma_f32_16x16x32_bf16 v[172:175], v[80:83], v[60:63], v[172:175]
    v_mfma_f32_16x16x32_bf16 v[176:179], v[80:83], v[64:67], v[176:179]
    v_mfma_f32_16x16x32_bf16 v[180:183], v[84:87], v[60:63], v[180:183]
    v_mfma_f32_16x16x32_bf16 v[184:187], v[84:87], v[64:67], v[184:187]
    v_mfma_f32_16x16x32_bf16 v[188:191], v[88:91], v[60:63], v[188:191]
    v_mfma_f32_16x16x32_bf16 v[192:195], v[88:91], v[64:67], v[192:195]
    v_mfma_f32_16x16x32_bf16 v[196:199], v[92:95], v[60:63], v[196:199]
    v_mfma_f32_16x16x32_bf16 v[200:203], v[92:95], v[64:67], v[200:203]
    v_mfma_f32_16x16x32_bf16 v[204:207], v[96:99], v[52:55], v[204:207]
    v_mfma_f32_16x16x32_bf16 v[208:211], v[100:103], v[52:55], v[208:211]
    s_waitcnt lgkmcnt(0)
    s_barrier
    v_mfma_f32_16x16x32_bf16 v[212:215], v[52:55], v[104:107], v[212:215]
    ds_read_b128 v[60:63], v28 offset:32768
    ds_read_b128 v[64:67], v28 offset:34816
    v_mfma_f32_16x16x32_bf16 v[220:223], v[104:107], v[104:107], v[220:223]
    ds_read_b64_tr_b16 v[68:69], v43 offset:32768
    ds_read_b64_tr_b16 v[70:71], v43 offset:33792
    v_mfma_f32_16x16x32_bf16 v[216:219], v[52:55], v[108:111], v[216:219]
    ds_read_b64_tr_b16 v[72:73], v44 offset:32768
    ds_read_b64_tr_b16 v[74:75], v44 offset:33792
    v_mfma_f32_16x16x32_bf16 v[224:227], v[108:111], v[108:111], v[224:227]
    ds_read_b64_tr_b16 v[76:77], v45 offset:32768
    ds_read_b64_tr_b16 v[78:79], v45 offset:33792
    v_mfma_f32_16x16x32_bf16 v[148:151], v[112:115], v[104:107], v[148:151]
    ds_read_b64_tr_b16 v[80:81], v46 offset:32768
    ds_read_b64_tr_b16 v[82:83], v46 offset:33792
    v_mfma_f32_16x16x32_bf16 v[152:155], v[112:115], v[108:111], v[152:155]
    ds_read_b64_tr_b16 v[84:85], v47 offset:32768
    ds_read_b64_tr_b16 v[86:87], v47 offset:33792
    v_mfma_f32_16x16x32_bf16 v[156:159], v[116:119], v[104:107], v[156:159]
    ds_read_b64_tr_b16 v[88:89], v48 offset:32768
    ds_read_b64_tr_b16 v[90:91], v48 offset:33792
    v_mfma_f32_16x16x32_bf16 v[160:163], v[116:119], v[108:111], v[160:163]
    ds_read_b64_tr_b16 v[92:93], v49 offset:32768
    ds_read_b64_tr_b16 v[94:95], v49 offset:33792
    v_mfma_f32_16x16x32_bf16 v[164:167], v[120:123], v[104:107], v[164:167]
    ds_read_b64_tr_b16 v[96:97], v50 offset:32768
    ds_read_b64_tr_b16 v[98:99], v50 offset:33792
    v_mfma_f32_16x16x32_bf16 v[168:171], v[120:123], v[108:111], v[168:171]
    ds_read_b64_tr_b16 v[100:101], v51 offset:32768
    ds_read_b64_tr_b16 v[102:103], v51 offset:33792
    v_mfma_f32_16x16x32_bf16 v[172:175], v[124:127], v[104:107], v[172:175]
    v_mfma_f32_16x16x32_bf16 v[176:179], v[124:127], v[108:111], v[176:179]
    v_mfma_f32_16x16x32_bf16 v[180:183], v[128:131], v[104:107], v[180:183]
    v_mfma_f32_16x16x32_bf16 v[184:187], v[128:131], v[108:111], v[184:187]
    v_mfma_f32_16x16x32_bf16 v[188:191], v[132:135], v[104:107], v[188:191]
    v_mfma_f32_16x16x32_bf16 v[192:195], v[132:135], v[108:111], v[192:195]
    v_mfma_f32_16x16x32_bf16 v[196:199], v[136:139], v[104:107], v[196:199]
    v_mfma_f32_16x16x32_bf16 v[200:203], v[136:139], v[108:111], v[200:203]
    v_mfma_f32_16x16x32_bf16 v[204:207], v[140:143], v[52:55], v[204:207]
    v_mfma_f32_16x16x32_bf16 v[208:211], v[144:147], v[52:55], v[208:211]
    s_waitcnt lgkmcnt(0)
    v_mfma_f32_16x16x32_bf16 v[212:215], v[52:55], v[60:63], v[212:215]
    ds_read_b128 v[104:107], v29 offset:32768
    ds_read_b128 v[108:111], v29 offset:34816
    v_mfma_f32_16x16x32_bf16 v[220:223], v[60:63], v[60:63], v[220:223]
    ds_read_b64_tr_b16 v[112:113], v43 offset:40960
    ds_read_b64_tr_b16 v[114:115], v43 offset:41984
    v_mfma_f32_16x16x32_bf16 v[216:219], v[52:55], v[64:67], v[216:219]
    ds_read_b64_tr_b16 v[116:117], v44 offset:40960
    ds_read_b64_tr_b16 v[118:119], v44 offset:41984
    v_mfma_f32_16x16x32_bf16 v[224:227], v[64:67], v[64:67], v[224:227]
    ds_read_b64_tr_b16 v[120:121], v45 offset:40960
    ds_read_b64_tr_b16 v[122:123], v45 offset:41984
    v_mfma_f32_16x16x32_bf16 v[148:151], v[68:71], v[60:63], v[148:151]
    ds_read_b64_tr_b16 v[124:125], v46 offset:40960
    ds_read_b64_tr_b16 v[126:127], v46 offset:41984
    v_mfma_f32_16x16x32_bf16 v[152:155], v[68:71], v[64:67], v[152:155]
    ds_read_b64_tr_b16 v[128:129], v47 offset:40960
    ds_read_b64_tr_b16 v[130:131], v47 offset:41984
    v_mfma_f32_16x16x32_bf16 v[156:159], v[72:75], v[60:63], v[156:159]
    ds_read_b64_tr_b16 v[132:133], v48 offset:40960
    ds_read_b64_tr_b16 v[134:135], v48 offset:41984
    v_mfma_f32_16x16x32_bf16 v[160:163], v[72:75], v[64:67], v[160:163]
    ds_read_b64_tr_b16 v[136:137], v49 offset:40960
    ds_read_b64_tr_b16 v[138:139], v49 offset:41984
    v_mfma_f32_16x16x32_bf16 v[164:167], v[76:79], v[60:63], v[164:167]
    ds_read_b64_tr_b16 v[140:141], v50 offset:40960
    ds_read_b64_tr_b16 v[142:143], v50 offset:41984
    v_mfma_f32_16x16x32_bf16 v[168:171], v[76:79], v[64:67], v[168:171]
    ds_read_b64_tr_b16 v[144:145], v51 offset:40960
    ds_read_b64_tr_b16 v[146:147], v51 offset:41984
    v_mfma_f32_16x16x32_bf16 v[172:175], v[80:83], v[60:63], v[172:175]
    v_mfma_f32_16x16x32_bf16 v[176:179], v[80:83], v[64:67], v[176:179]
    v_mfma_f32_16x16x32_bf16 v[180:183], v[84:87], v[60:63], v[180:183]
    v_mfma_f32_16x16x32_bf16 v[184:187], v[84:87], v[64:67], v[184:187]
    v_mfma_f32_16x16x32_bf16 v[188:191], v[88:91], v[60:63], v[188:191]
    v_mfma_f32_16x16x32_bf16 v[192:195], v[88:91], v[64:67], v[192:195]
    v_mfma_f32_16x16x32_bf16 v[196:199], v[92:95], v[60:63], v[196:199]
    v_mfma_f32_16x16x32_bf16 v[200:203], v[92:95], v[64:67], v[200:203]
    v_mfma_f32_16x16x32_bf16 v[204:207], v[96:99], v[52:55], v[204:207]
    v_mfma_f32_16x16x32_bf16 v[208:211], v[100:103], v[52:55], v[208:211]
    s_waitcnt lgkmcnt(0)
    s_barrier
    v_mfma_f32_16x16x32_bf16 v[212:215], v[52:55], v[104:107], v[212:215]
    ds_read_b128 v[60:63], v26
    ds_read_b128 v[64:67], v26 offset:2048
    v_mfma_f32_16x16x32_bf16 v[220:223], v[104:107], v[104:107], v[220:223]
    ds_read_b64_tr_b16 v[68:69], v34
    ds_read_b64_tr_b16 v[70:71], v34 offset:1024
    v_mfma_f32_16x16x32_bf16 v[216:219], v[52:55], v[108:111], v[216:219]
    ds_read_b64_tr_b16 v[72:73], v35
    ds_read_b64_tr_b16 v[74:75], v35 offset:1024
    v_mfma_f32_16x16x32_bf16 v[224:227], v[108:111], v[108:111], v[224:227]
    ds_read_b64_tr_b16 v[76:77], v36
    ds_read_b64_tr_b16 v[78:79], v36 offset:1024
    v_mfma_f32_16x16x32_bf16 v[148:151], v[112:115], v[104:107], v[148:151]
    ds_read_b64_tr_b16 v[80:81], v37
    ds_read_b64_tr_b16 v[82:83], v37 offset:1024
    v_mfma_f32_16x16x32_bf16 v[152:155], v[112:115], v[108:111], v[152:155]
    ds_read_b64_tr_b16 v[84:85], v38
    ds_read_b64_tr_b16 v[86:87], v38 offset:1024
    v_mfma_f32_16x16x32_bf16 v[156:159], v[116:119], v[104:107], v[156:159]
    ds_read_b64_tr_b16 v[88:89], v39
    ds_read_b64_tr_b16 v[90:91], v39 offset:1024
    v_mfma_f32_16x16x32_bf16 v[160:163], v[116:119], v[108:111], v[160:163]
    ds_read_b64_tr_b16 v[92:93], v40
    ds_read_b64_tr_b16 v[94:95], v40 offset:1024
    v_mfma_f32_16x16x32_bf16 v[164:167], v[120:123], v[104:107], v[164:167]
    ds_read_b64_tr_b16 v[96:97], v41
    ds_read_b64_tr_b16 v[98:99], v41 offset:1024
    v_mfma_f32_16x16x32_bf16 v[168:171], v[120:123], v[108:111], v[168:171]
    ds_read_b64_tr_b16 v[100:101], v42
    ds_read_b64_tr_b16 v[102:103], v42 offset:1024
    v_mfma_f32_16x16x32_bf16 v[172:175], v[124:127], v[104:107], v[172:175]
    v_mfma_f32_16x16x32_bf16 v[176:179], v[124:127], v[108:111], v[176:179]
    v_mfma_f32_16x16x32_bf16 v[180:183], v[128:131], v[104:107], v[180:183]
    v_mfma_f32_16x16x32_bf16 v[184:187], v[128:131], v[108:111], v[184:187]
    v_mfma_f32_16x16x32_bf16 v[188:191], v[132:135], v[104:107], v[188:191]
    v_mfma_f32_16x16x32_bf16 v[192:195], v[132:135], v[108:111], v[192:195]
    v_mfma_f32_16x16x32_bf16 v[196:199], v[136:139], v[104:107], v[196:199]
    v_mfma_f32_16x16x32_bf16 v[200:203], v[136:139], v[108:111], v[200:203]
    v_mfma_f32_16x16x32_bf16 v[204:207], v[140:143], v[52:55], v[204:207]
    v_mfma_f32_16x16x32_bf16 v[208:211], v[144:147], v[52:55], v[208:211]
    s_waitcnt lgkmcnt(0)
    v_mfma_f32_16x16x32_bf16 v[212:215], v[52:55], v[60:63], v[212:215]
    ds_read_b128 v[104:107], v27
    ds_read_b128 v[108:111], v27 offset:2048
    v_mfma_f32_16x16x32_bf16 v[220:223], v[60:63], v[60:63], v[220:223]
    ds_read_b64_tr_b16 v[112:113], v34 offset:8192
    ds_read_b64_tr_b16 v[114:115], v34 offset:9216
    v_mfma_f32_16x16x32_bf16 v[216:219], v[52:55], v[64:67], v[216:219]
    ds_read_b64_tr_b16 v[116:117], v35 offset:8192
    ds_read_b64_tr_b16 v[118:119], v35 offset:9216
    v_mfma_f32_16x16x32_bf16 v[224:227], v[64:67], v[64:67], v[224:227]
    ds_read_b64_tr_b16 v[120:121], v36 offset:8192
    ds_read_b64_tr_b16 v[122:123], v36 offset:9216
    v_mfma_f32_16x16x32_bf16 v[148:151], v[68:71], v[60:63], v[148:151]
    ds_read_b64_tr_b16 v[124:125], v37 offset:8192
    ds_read_b64_tr_b16 v[126:127], v37 offset:9216
    v_mfma_f32_16x16x32_bf16 v[152:155], v[68:71], v[64:67], v[152:155]
    ds_read_b64_tr_b16 v[128:129], v38 offset:8192
    ds_read_b64_tr_b16 v[130:131], v38 offset:9216
    v_mfma_f32_16x16x32_bf16 v[156:159], v[72:75], v[60:63], v[156:159]
    ds_read_b64_tr_b16 v[132:133], v39 offset:8192
    ds_read_b64_tr_b16 v[134:135], v39 offset:9216
    v_mfma_f32_16x16x32_bf16 v[160:163], v[72:75], v[64:67], v[160:163]
    ds_read_b64_tr_b16 v[136:137], v40 offset:8192
    ds_read_b64_tr_b16 v[138:139], v40 offset:9216
    v_mfma_f32_16x16x32_bf16 v[164:167], v[76:79], v[60:63], v[164:167]
    ds_read_b64_tr_b16 v[140:141], v41 offset:8192
    ds_read_b64_tr_b16 v[142:143], v41 offset:9216
    v_mfma_f32_16x16x32_bf16 v[168:171], v[76:79], v[64:67], v[168:171]
    ds_read_b64_tr_b16 v[144:145], v42 offset:8192
    ds_read_b64_tr_b16 v[146:147], v42 offset:9216
    v_mfma_f32_16x16x32_bf16 v[172:175], v[80:83], v[60:63], v[172:175]
    v_mfma_f32_16x16x32_bf16 v[176:179], v[80:83], v[64:67], v[176:179]
    v_mfma_f32_16x16x32_bf16 v[180:183], v[84:87], v[60:63], v[180:183]
    v_mfma_f32_16x16x32_bf16 v[184:187], v[84:87], v[64:67], v[184:187]
    v_mfma_f32_16x16x32_bf16 v[188:191], v[88:91], v[60:63], v[188:191]
    v_mfma_f32_16x16x32_bf16 v[192:195], v[88:91], v[64:67], v[192:195]
    v_mfma_f32_16x16x32_bf16 v[196:199], v[92:95], v[60:63], v[196:199]
    v_mfma_f32_16x16x32_bf16 v[200:203], v[92:95], v[64:67], v[200:203]
    v_mfma_f32_16x16x32_bf16 v[204:207], v[96:99], v[52:55], v[204:207]
    v_mfma_f32_16x16x32_bf16 v[208:211], v[100:103], v[52:55], v[208:211]
    s_waitcnt lgkmcnt(0)
    s_barrier
    v_mfma_f32_16x16x32_bf16 v[212:215], v[52:55], v[104:107], v[212:215]
    ds_read_b128 v[60:63], v26 offset:32768
    ds_read_b128 v[64:67], v26 offset:34816
    v_mfma_f32_16x16x32_bf16 v[220:223], v[104:107], v[104:107], v[220:223]
    ds_read_b64_tr_b16 v[68:69], v34 offset:32768
    ds_read_b64_tr_b16 v[70:71], v34 offset:33792
    v_mfma_f32_16x16x32_bf16 v[216:219], v[52:55], v[108:111], v[216:219]
    ds_read_b64_tr_b16 v[72:73], v35 offset:32768
    ds_read_b64_tr_b16 v[74:75], v35 offset:33792
    v_mfma_f32_16x16x32_bf16 v[224:227], v[108:111], v[108:111], v[224:227]
    ds_read_b64_tr_b16 v[76:77], v36 offset:32768
    ds_read_b64_tr_b16 v[78:79], v36 offset:33792
    v_mfma_f32_16x16x32_bf16 v[148:151], v[112:115], v[104:107], v[148:151]
    ds_read_b64_tr_b16 v[80:81], v37 offset:32768
    ds_read_b64_tr_b16 v[82:83], v37 offset:33792
    v_mfma_f32_16x16x32_bf16 v[152:155], v[112:115], v[108:111], v[152:155]
    ds_read_b64_tr_b16 v[84:85], v38 offset:32768
    ds_read_b64_tr_b16 v[86:87], v38 offset:33792
    v_mfma_f32_16x16x32_bf16 v[156:159], v[116:119], v[104:107], v[156:159]
    ds_read_b64_tr_b16 v[88:89], v39 offset:32768
    ds_read_b64_tr_b16 v[90:91], v39 offset:33792
    v_mfma_f32_16x16x32_bf16 v[160:163], v[116:119], v[108:111], v[160:163]
    ds_read_b64_tr_b16 v[92:93], v40 offset:32768
    ds_read_b64_tr_b16 v[94:95], v40 offset:33792
    v_mfma_f32_16x16x32_bf16 v[164:167], v[120:123], v[104:107], v[164:167]
    ds_read_b64_tr_b16 v[96:97], v41 offset:32768
    ds_read_b64_tr_b16 v[98:99], v41 offset:33792
    v_mfma_f32_16x16x32_bf16 v[168:171], v[120:123], v[108:111], v[168:171]
    ds_read_b64_tr_b16 v[100:101], v42 offset:32768
    ds_read_b64_tr_b16 v[102:103], v42 offset:33792
    v_mfma_f32_16x16x32_bf16 v[172:175], v[124:127], v[104:107], v[172:175]
    v_mfma_f32_16x16x32_bf16 v[176:179], v[124:127], v[108:111], v[176:179]
    v_mfma_f32_16x16x32_bf16 v[180:183], v[128:131], v[104:107], v[180:183]
    v_mfma_f32_16x16x32_bf16 v[184:187], v[128:131], v[108:111], v[184:187]
    v_mfma_f32_16x16x32_bf16 v[188:191], v[132:135], v[104:107], v[188:191]
    v_mfma_f32_16x16x32_bf16 v[192:195], v[132:135], v[108:111], v[192:195]
    v_mfma_f32_16x16x32_bf16 v[196:199], v[136:139], v[104:107], v[196:199]
    v_mfma_f32_16x16x32_bf16 v[200:203], v[136:139], v[108:111], v[200:203]
    v_mfma_f32_16x16x32_bf16 v[204:207], v[140:143], v[52:55], v[204:207]
    v_mfma_f32_16x16x32_bf16 v[208:211], v[144:147], v[52:55], v[208:211]
    s_waitcnt lgkmcnt(0)
    v_mfma_f32_16x16x32_bf16 v[212:215], v[52:55], v[60:63], v[212:215]
    ds_read_b128 v[104:107], v27 offset:32768
    ds_read_b128 v[108:111], v27 offset:34816
    v_mfma_f32_16x16x32_bf16 v[220:223], v[60:63], v[60:63], v[220:223]
    ds_read_b64_tr_b16 v[112:113], v34 offset:40960
    ds_read_b64_tr_b16 v[114:115], v34 offset:41984
    v_mfma_f32_16x16x32_bf16 v[216:219], v[52:55], v[64:67], v[216:219]
    ds_read_b64_tr_b16 v[116:117], v35 offset:40960
    ds_read_b64_tr_b16 v[118:119], v35 offset:41984
    v_mfma_f32_16x16x32_bf16 v[224:227], v[64:67], v[64:67], v[224:227]
    ds_read_b64_tr_b16 v[120:121], v36 offset:40960
    ds_read_b64_tr_b16 v[122:123], v36 offset:41984
    v_mfma_f32_16x16x32_bf16 v[148:151], v[68:71], v[60:63], v[148:151]
    ds_read_b64_tr_b16 v[124:125], v37 offset:40960
    ds_read_b64_tr_b16 v[126:127], v37 offset:41984
    v_mfma_f32_16x16x32_bf16 v[152:155], v[68:71], v[64:67], v[152:155]
    ds_read_b64_tr_b16 v[128:129], v38 offset:40960
    ds_read_b64_tr_b16 v[130:131], v38 offset:41984
    v_mfma_f32_16x16x32_bf16 v[156:159], v[72:75], v[60:63], v[156:159]
    ds_read_b64_tr_b16 v[132:133], v39 offset:40960
    ds_read_b64_tr_b16 v[134:135], v39 offset:41984
    v_mfma_f32_16x16x32_bf16 v[160:163], v[72:75], v[64:67], v[160:163]
    ds_read_b64_tr_b16 v[136:137], v40 offset:40960
    ds_read_b64_tr_b16 v[138:139], v40 offset:41984
    v_mfma_f32_16x16x32_bf16 v[164:167], v[76:79], v[60:63], v[164:167]
    ds_read_b64_tr_b16 v[140:141], v41 offset:40960
    ds_read_b64_tr_b16 v[142:143], v41 offset:41984
    v_mfma_f32_16x16x32_bf16 v[168:171], v[76:79], v[64:67], v[168:171]
    ds_read_b64_tr_b16 v[144:145], v42 offset:40960
    ds_read_b64_tr_b16 v[146:147], v42 offset:41984
    v_mfma_f32_16x16x32_bf16 v[172:175], v[80:83], v[60:63], v[172:175]
    v_mfma_f32_16x16x32_bf16 v[176:179], v[80:83], v[64:67], v[176:179]
    v_mfma_f32_16x16x32_bf16 v[180:183], v[84:87], v[60:63], v[180:183]
    v_mfma_f32_16x16x32_bf16 v[184:187], v[84:87], v[64:67], v[184:187]
    v_mfma_f32_16x16x32_bf16 v[188:191], v[88:91], v[60:63], v[188:191]
    v_mfma_f32_16x16x32_bf16 v[192:195], v[88:91], v[64:67], v[192:195]
    v_mfma_f32_16x16x32_bf16 v[196:199], v[92:95], v[60:63], v[196:199]
    v_mfma_f32_16x16x32_bf16 v[200:203], v[92:95], v[64:67], v[200:203]
    v_mfma_f32_16x16x32_bf16 v[204:207], v[96:99], v[52:55], v[204:207]
    v_mfma_f32_16x16x32_bf16 v[208:211], v[100:103], v[52:55], v[208:211]
    s_waitcnt lgkmcnt(0)
    s_barrier
    v_mfma_f32_16x16x32_bf16 v[212:215], v[52:55], v[104:107], v[212:215]
    ds_read_b128 v[60:63], v28
    ds_read_b128 v[64:67], v28 offset:2048
    v_mfma_f32_16x16x32_bf16 v[220:223], v[104:107], v[104:107], v[220:223]
    ds_read_b64_tr_b16 v[68:69], v43
    ds_read_b64_tr_b16 v[70:71], v43 offset:1024
    v_mfma_f32_16x16x32_bf16 v[216:219], v[52:55], v[108:111], v[216:219]
    ds_read_b64_tr_b16 v[72:73], v44
    ds_read_b64_tr_b16 v[74:75], v44 offset:1024
    v_mfma_f32_16x16x32_bf16 v[224:227], v[108:111], v[108:111], v[224:227]
    ds_read_b64_tr_b16 v[76:77], v45
    ds_read_b64_tr_b16 v[78:79], v45 offset:1024
    v_mfma_f32_16x16x32_bf16 v[148:151], v[112:115], v[104:107], v[148:151]
    ds_read_b64_tr_b16 v[80:81], v46
    ds_read_b64_tr_b16 v[82:83], v46 offset:1024
    v_mfma_f32_16x16x32_bf16 v[152:155], v[112:115], v[108:111], v[152:155]
    ds_read_b64_tr_b16 v[84:85], v47
    ds_read_b64_tr_b16 v[86:87], v47 offset:1024
    v_mfma_f32_16x16x32_bf16 v[156:159], v[116:119], v[104:107], v[156:159]
    ds_read_b64_tr_b16 v[88:89], v48
    ds_read_b64_tr_b16 v[90:91], v48 offset:1024
    v_mfma_f32_16x16x32_bf16 v[160:163], v[116:119], v[108:111], v[160:163]
    ds_read_b64_tr_b16 v[92:93], v49
    ds_read_b64_tr_b16 v[94:95], v49 offset:1024
    v_mfma_f32_16x16x32_bf16 v[164:167], v[120:123], v[104:107], v[164:167]
    ds_read_b64_tr_b16 v[96:97], v50
    ds_read_b64_tr_b16 v[98:99], v50 offset:1024
    v_mfma_f32_16x16x32_bf16 v[168:171], v[120:123], v[108:111], v[168:171]
    ds_read_b64_tr_b16 v[100:101], v51
    ds_read_b64_tr_b16 v[102:103], v51 offset:1024
    v_mfma_f32_16x16x32_bf16 v[172:175], v[124:127], v[104:107], v[172:175]
    v_mfma_f32_16x16x32_bf16 v[176:179], v[124:127], v[108:111], v[176:179]
    v_mfma_f32_16x16x32_bf16 v[180:183], v[128:131], v[104:107], v[180:183]
    v_mfma_f32_16x16x32_bf16 v[184:187], v[128:131], v[108:111], v[184:187]
    v_mfma_f32_16x16x32_bf16 v[188:191], v[132:135], v[104:107], v[188:191]
    v_mfma_f32_16x16x32_bf16 v[192:195], v[132:135], v[108:111], v[192:195]
    v_mfma_f32_16x16x32_bf16 v[196:199], v[136:139], v[104:107], v[196:199]
    v_mfma_f32_16x16x32_bf16 v[200:203], v[136:139], v[108:111], v[200:203]
    v_mfma_f32_16x16x32_bf16 v[204:207], v[140:143], v[52:55], v[204:207]
    v_mfma_f32_16x16x32_bf16 v[208:211], v[144:147], v[52:55], v[208:211]
    s_waitcnt lgkmcnt(0)
    v_mfma_f32_16x16x32_bf16 v[212:215], v[52:55], v[60:63], v[212:215]
    ds_read_b128 v[104:107], v29
    ds_read_b128 v[108:111], v29 offset:2048
    v_mfma_f32_16x16x32_bf16 v[220:223], v[60:63], v[60:63], v[220:223]
    ds_read_b64_tr_b16 v[112:113], v43 offset:8192
    ds_read_b64_tr_b16 v[114:115], v43 offset:9216
    v_mfma_f32_16x16x32_bf16 v[216:219], v[52:55], v[64:67], v[216:219]
    ds_read_b64_tr_b16 v[116:117], v44 offset:8192
    ds_read_b64_tr_b16 v[118:119], v44 offset:9216
    v_mfma_f32_16x16x32_bf16 v[224:227], v[64:67], v[64:67], v[224:227]
    ds_read_b64_tr_b16 v[120:121], v45 offset:8192
    ds_read_b64_tr_b16 v[122:123], v45 offset:9216
    v_mfma_f32_16x16x32_bf16 v[148:151], v[68:71], v[60:63], v[148:151]
    ds_read_b64_tr_b16 v[124:125], v46 offset:8192
    ds_read_b64_tr_b16 v[126:127], v46 offset:9216
    v_mfma_f32_16x16x32_bf16 v[152:155], v[68:71], v[64:67], v[152:155]
    ds_read_b64_tr_b16 v[128:129], v47 offset:8192
    ds_read_b64_tr_b16 v[130:131], v47 offset:9216
    v_mfma_f32_16x16x32_bf16 v[156:159], v[72:75], v[60:63], v[156:159]
    ds_read_b64_tr_b16 v[132:133], v48 offset:8192
    ds_read_b64_tr_b16 v[134:135], v48 offset:9216
    v_mfma_f32_16x16x32_bf16 v[160:163], v[72:75], v[64:67], v[160:163]
    ds_read_b64_tr_b16 v[136:137], v49 offset:8192
    ds_read_b64_tr_b16 v[138:139], v49 offset:9216
    v_mfma_f32_16x16x32_bf16 v[164:167], v[76:79], v[60:63], v[164:167]
    ds_read_b64_tr_b16 v[140:141], v50 offset:8192
    ds_read_b64_tr_b16 v[142:143], v50 offset:9216
    v_mfma_f32_16x16x32_bf16 v[168:171], v[76:79], v[64:67], v[168:171]
    ds_read_b64_tr_b16 v[144:145], v51 offset:8192
    ds_read_b64_tr_b16 v[146:147], v51 offset:9216
    v_mfma_f32_16x16x32_bf16 v[172:175], v[80:83], v[60:63], v[172:175]
    v_mfma_f32_16x16x32_bf16 v[176:179], v[80:83], v[64:67], v[176:179]
    v_mfma_f32_16x16x32_bf16 v[180:183], v[84:87], v[60:63], v[180:183]
    v_mfma_f32_16x16x32_bf16 v[184:187], v[84:87], v[64:67], v[184:187]
    v_mfma_f32_16x16x32_bf16 v[188:191], v[88:91], v[60:63], v[188:191]
    v_mfma_f32_16x16x32_bf16 v[192:195], v[88:91], v[64:67], v[192:195]
    v_mfma_f32_16x16x32_bf16 v[196:199], v[92:95], v[60:63], v[196:199]
    v_mfma_f32_16x16x32_bf16 v[200:203], v[92:95], v[64:67], v[200:203]
    v_mfma_f32_16x16x32_bf16 v[204:207], v[96:99], v[52:55], v[204:207]
    v_mfma_f32_16x16x32_bf16 v[208:211], v[100:103], v[52:55], v[208:211]
    s_waitcnt lgkmcnt(0)
    s_barrier
    v_mfma_f32_16x16x32_bf16 v[212:215], v[52:55], v[104:107], v[212:215]
    ds_read_b128 v[60:63], v28 offset:32768
    ds_read_b128 v[64:67], v28 offset:34816
    v_mfma_f32_16x16x32_bf16 v[220:223], v[104:107], v[104:107], v[220:223]
    ds_read_b64_tr_b16 v[68:69], v43 offset:32768
    ds_read_b64_tr_b16 v[70:71], v43 offset:33792
    v_mfma_f32_16x16x32_bf16 v[216:219], v[52:55], v[108:111], v[216:219]
    ds_read_b64_tr_b16 v[72:73], v44 offset:32768
    ds_read_b64_tr_b16 v[74:75], v44 offset:33792
    v_mfma_f32_16x16x32_bf16 v[224:227], v[108:111], v[108:111], v[224:227]
    ds_read_b64_tr_b16 v[76:77], v45 offset:32768
    ds_read_b64_tr_b16 v[78:79], v45 offset:33792
    v_mfma_f32_16x16x32_bf16 v[148:151], v[112:115], v[104:107], v[148:151]
    ds_read_b64_tr_b16 v[80:81], v46 offset:32768
    ds_read_b64_tr_b16 v[82:83], v46 offset:33792
    v_mfma_f32_16x16x32_bf16 v[152:155], v[112:115], v[108:111], v[152:155]
    ds_read_b64_tr_b16 v[84:85], v47 offset:32768
    ds_read_b64_tr_b16 v[86:87], v47 offset:33792
    v_mfma_f32_16x16x32_bf16 v[156:159], v[116:119], v[104:107], v[156:159]
    ds_read_b64_tr_b16 v[88:89], v48 offset:32768
    ds_read_b64_tr_b16 v[90:91], v48 offset:33792
    v_mfma_f32_16x16x32_bf16 v[160:163], v[116:119], v[108:111], v[160:163]
    ds_read_b64_tr_b16 v[92:93], v49 offset:32768
    ds_read_b64_tr_b16 v[94:95], v49 offset:33792
    v_mfma_f32_16x16x32_bf16 v[164:167], v[120:123], v[104:107], v[164:167]
    ds_read_b64_tr_b16 v[96:97], v50 offset:32768
    ds_read_b64_tr_b16 v[98:99], v50 offset:33792
    v_mfma_f32_16x16x32_bf16 v[168:171], v[120:123], v[108:111], v[168:171]
    ds_read_b64_tr_b16 v[100:101], v51 offset:32768
    ds_read_b64_tr_b16 v[102:103], v51 offset:33792
    v_mfma_f32_16x16x32_bf16 v[172:175], v[124:127], v[104:107], v[172:175]
    v_mfma_f32_16x16x32_bf16 v[176:179], v[124:127], v[108:111], v[176:179]
    v_mfma_f32_16x16x32_bf16 v[180:183], v[128:131], v[104:107], v[180:183]
    v_mfma_f32_16x16x32_bf16 v[184:187], v[128:131], v[108:111], v[184:187]
    v_mfma_f32_16x16x32_bf16 v[188:191], v[132:135], v[104:107], v[188:191]
    v_mfma_f32_16x16x32_bf16 v[192:195], v[132:135], v[108:111], v[192:195]
    v_mfma_f32_16x16x32_bf16 v[196:199], v[136:139], v[104:107], v[196:199]
    v_mfma_f32_16x16x32_bf16 v[200:203], v[136:139], v[108:111], v[200:203]
    v_mfma_f32_16x16x32_bf16 v[204:207], v[140:143], v[52:55], v[204:207]
    v_mfma_f32_16x16x32_bf16 v[208:211], v[144:147], v[52:55], v[208:211]
    s_waitcnt lgkmcnt(0)
    v_mfma_f32_16x16x32_bf16 v[212:215], v[52:55], v[60:63], v[212:215]
    ds_read_b128 v[104:107], v29 offset:32768
    ds_read_b128 v[108:111], v29 offset:34816
    v_mfma_f32_16x16x32_bf16 v[220:223], v[60:63], v[60:63], v[220:223]
    ds_read_b64_tr_b16 v[112:113], v43 offset:40960
    ds_read_b64_tr_b16 v[114:115], v43 offset:41984
    v_mfma_f32_16x16x32_bf16 v[216:219], v[52:55], v[64:67], v[216:219]
    ds_read_b64_tr_b16 v[116:117], v44 offset:40960
    ds_read_b64_tr_b16 v[118:119], v44 offset:41984
    v_mfma_f32_16x16x32_bf16 v[224:227], v[64:67], v[64:67], v[224:227]
    ds_read_b64_tr_b16 v[120:121], v45 offset:40960
    ds_read_b64_tr_b16 v[122:123], v45 offset:41984
    v_mfma_f32_16x16x32_bf16 v[148:151], v[68:71], v[60:63], v[148:151]
    ds_read_b64_tr_b16 v[124:125], v46 offset:40960
    ds_read_b64_tr_b16 v[126:127], v46 offset:41984
    v_mfma_f32_16x16x32_bf16 v[152:155], v[68:71], v[64:67], v[152:155]
    ds_read_b64_tr_b16 v[128:129], v47 offset:40960
    ds_read_b64_tr_b16 v[130:131], v47 offset:41984
    v_mfma_f32_16x16x32_bf16 v[156:159], v[72:75], v[60:63], v[156:159]
    ds_read_b64_tr_b16 v[132:133], v48 offset:40960
    ds_read_b64_tr_b16 v[134:135], v48 offset:41984
    v_mfma_f32_16x16x32_bf16 v[160:163], v[72:75], v[64:67], v[160:163]
    ds_read_b64_tr_b16 v[136:137], v49 offset:40960
    ds_read_b64_tr_b16 v[138:139], v49 offset:41984
    v_mfma_f32_16x16x32_bf16 v[164:167], v[76:79], v[60:63], v[164:167]
    ds_read_b64_tr_b16 v[140:141], v50 offset:40960
    ds_read_b64_tr_b16 v[142:143], v50 offset:41984
    v_mfma_f32_16x16x32_bf16 v[168:171], v[76:79], v[64:67], v[168:171]
    ds_read_b64_tr_b16 v[144:145], v51 offset:40960
    ds_read_b64_tr_b16 v[146:147], v51 offset:41984
    v_mfma_f32_16x16x32_bf16 v[172:175], v[80:83], v[60:63], v[172:175]
    v_mfma_f32_16x16x32_bf16 v[176:179], v[80:83], v[64:67], v[176:179]
    v_mfma_f32_16x16x32_bf16 v[180:183], v[84:87], v[60:63], v[180:183]
    v_mfma_f32_16x16x32_bf16 v[184:187], v[84:87], v[64:67], v[184:187]
    v_mfma_f32_16x16x32_bf16 v[188:191], v[88:91], v[60:63], v[188:191]
    v_mfma_f32_16x16x32_bf16 v[192:195], v[88:91], v[64:67], v[192:195]
    v_mfma_f32_16x16x32_bf16 v[196:199], v[92:95], v[60:63], v[196:199]
    v_mfma_f32_16x16x32_bf16 v[200:203], v[92:95], v[64:67], v[200:203]
    v_mfma_f32_16x16x32_bf16 v[204:207], v[96:99], v[52:55], v[204:207]
    v_mfma_f32_16x16x32_bf16 v[208:211], v[100:103], v[52:55], v[208:211]
    s_waitcnt lgkmcnt(0)
    v_mfma_f32_16x16x32_bf16 v[212:215], v[52:55], v[104:107], v[212:215]
    v_mfma_f32_16x16x32_bf16 v[220:223], v[104:107], v[104:107], v[220:223]
    v_mfma_f32_16x16x32_bf16 v[216:219], v[52:55], v[108:111], v[216:219]
    v_mfma_f32_16x16x32_bf16 v[224:227], v[108:111], v[108:111], v[224:227]
    v_mfma_f32_16x16x32_bf16 v[148:151], v[112:115], v[104:107], v[148:151]
    v_mfma_f32_16x16x32_bf16 v[152:155], v[112:115], v[108:111], v[152:155]
    v_mfma_f32_16x16x32_bf16 v[156:159], v[116:119], v[104:107], v[156:159]
    v_mfma_f32_16x16x32_bf16 v[160:163], v[116:119], v[108:111], v[160:163]
    v_mfma_f32_16x16x32_bf16 v[164:167], v[120:123], v[104:107], v[164:167]
    v_mfma_f32_16x16x32_bf16 v[168:171], v[120:123], v[108:111], v[168:171]
    v_mfma_f32_16x16x32_bf16 v[172:175], v[124:127], v[104:107], v[172:175]
    v_mfma_f32_16x16x32_bf16 v[176:179], v[124:127], v[108:111], v[176:179]
    v_mfma_f32_16x16x32_bf16 v[180:183], v[128:131], v[104:107], v[180:183]
    v_mfma_f32_16x16x32_bf16 v[184:187], v[128:131], v[108:111], v[184:187]
    v_mfma_f32_16x16x32_bf16 v[188:191], v[132:135], v[104:107], v[188:191]
    v_mfma_f32_16x16x32_bf16 v[192:195], v[132:135], v[108:111], v[192:195]
    v_mfma_f32_16x16x32_bf16 v[196:199], v[136:139], v[104:107], v[196:199]
    v_mfma_f32_16x16x32_bf16 v[200:203], v[136:139], v[108:111], v[200:203]
    v_mfma_f32_16x16x32_bf16 v[204:207], v[140:143], v[52:55], v[204:207]
    v_mfma_f32_16x16x32_bf16 v[208:211], v[144:147], v[52:55], v[208:211]
    s_mov_b64 exec, s[68:69]
    s_nop 5
    ds_write_b128 v56, v[204:207]
    ds_write_b128 v57, v[208:211]
    s_mov_b64 exec, -1
    ds_write_b128 v11, v[152:155]
    ds_write_b128 v11, v[160:163] offset:1024
    ds_write_b128 v11, v[168:171] offset:2048
    ds_write_b128 v11, v[176:179] offset:3072
    ds_write_b128 v11, v[184:187] offset:4096
    ds_write_b128 v11, v[192:195] offset:5120
    ds_write_b128 v11, v[200:203] offset:6144
    v_cndmask_b32 v5, v220, v221, s[62:63]
    v_cndmask_b32 v5, v5, v222, s[64:65]
    v_cndmask_b32 v5, v5, v223, s[66:67]
    ds_bpermute_b32 v104, v58, v5
    v_cndmask_b32 v6, v224, v225, s[62:63]
    v_cndmask_b32 v6, v6, v226, s[64:65]
    v_cndmask_b32 v6, v6, v227, s[66:67]
    ds_bpermute_b32 v105, v58, v6
    s_waitcnt lgkmcnt(0)
    v_mul_f32 v110, 0x3b000000, v212
    v_mul_f32 v111, 0x3b000000, v216
    v_mul_f32 v104, 0x3b000000, v104
    v_mul_f32 v105, 0x3b000000, v105
    v_fma_f32 v104, -v110, v110, v104
    v_fma_f32 v105, -v111, v111, v105
    v_max_f32 v104, 0, v104
    v_max_f32 v105, 0, v105
    v_cvt_pk_bf16_f32 v5, v110, v104
    v_cvt_pk_bf16_f32 v6, v111, v105
    v_lshlrev_b32 v112, 16, v5
    v_lshlrev_b32 v113, 16, v6
    v_and_b32 v114, 4294901760, v5
    v_and_b32 v115, 4294901760, v6
    v_add_f32 v114, 0x3727c5ac, v114
    v_add_f32 v115, 0x3727c5ac, v115
    v_cvt_pk_bf16_f32 v5, v114, v114
    v_cvt_pk_bf16_f32 v6, v115, v115
    v_lshlrev_b32 v114, 16, v5
    v_lshlrev_b32 v115, 16, v6
    v_sqrt_f32 v114, v114
    v_sqrt_f32 v115, v115
    v_cvt_pk_bf16_f32 v5, v114, v114
    v_cvt_pk_bf16_f32 v6, v115, v115
    v_lshlrev_b32 v114, 16, v5
    v_lshlrev_b32 v115, 16, v6
    v_rcp_f32 v116, v114
    v_rcp_f32 v117, v115
    v_sub_f32 v110, v110, v112
    v_sub_f32 v111, v111, v113
    v_mul_f32 v110, v110, v116
    v_mul_f32 v111, v111, v117
    v_mul_f32 v104, v104, v116
    v_mul_f32 v105, v105, v117
    v_mul_f32 v104, v104, v116
    v_mul_f32 v105, v105, v117
    v_cvt_pk_bf16_f32 v5, v110, v104
    v_cvt_pk_bf16_f32 v6, v111, v105
    v_lshlrev_b32 v110, 16, v5
    v_lshlrev_b32 v111, 16, v6
    v_and_b32 v104, 4294901760, v5
    v_and_b32 v105, 4294901760, v6
    v_add_f32 v104, 0x3727c5ac, v104
    v_add_f32 v105, 0x3727c5ac, v105
    v_cvt_pk_bf16_f32 v5, v104, v104
    v_cvt_pk_bf16_f32 v6, v105, v105
    v_lshlrev_b32 v104, 16, v5
    v_lshlrev_b32 v105, 16, v6
    v_sqrt_f32 v104, v104
    v_sqrt_f32 v105, v105
    v_cvt_pk_bf16_f32 v5, v104, v104
    v_cvt_pk_bf16_f32 v6, v105, v105
    v_lshlrev_b32 v104, 16, v5
    v_lshlrev_b32 v105, 16, v6
    v_fma_f32 v106, v110, v114, v112
    v_fma_f32 v108, v111, v115, v113
    v_mul_f32 v104, v104, v114
    v_mul_f32 v105, v105, v115
    v_rcp_f32 v107, v104
    v_rcp_f32 v109, v105
    ds_write_b64 v11, v[108:109] offset:7168
    s_waitcnt lgkmcnt(0)
    s_barrier
    ds_read_b128 v[68:71], v10
    ds_read_b128 v[72:75], v10 offset:64
    ds_read_b128 v[76:79], v10 offset:128
    ds_read_b128 v[80:83], v10 offset:192
    ds_read_b128 v[84:87], v10 offset:256
    ds_read_b128 v[88:91], v10 offset:320
    ds_read_b128 v[92:95], v10 offset:384
    s_waitcnt vmcnt(0) lgkmcnt(0)
    v_mov_b32 v118, 0xc0135761
    v_mov_b32 v120, 1.0
    s_mov_b32 s70, 0xbdd2d3e8
    v_mov_b32 v119, 0xc0135761
    v_mov_b32 v121, 1.0
    s_mov_b32 s71, 0xbdd2d3e8
    v_lshlrev_b32 v122, 16, v12
    v_and_b32 v123, 4294901760, v12
    v_lshlrev_b32 v124, 16, v13
    v_and_b32 v125, 4294901760, v13
    v_pk_fma_f32 v[148:149], v[68:69], v[106:107], v[148:149] op_sel_hi:[1,0,1] neg_lo:[0,1,0] neg_hi:[0,1,0]
    v_pk_fma_f32 v[150:151], v[70:71], v[106:107], v[150:151] op_sel_hi:[1,0,1] neg_lo:[0,1,0] neg_hi:[0,1,0]
    v_pk_mul_f32 v[148:149], v[148:149], v[106:107] op_sel:[0,1] op_sel_hi:[1,1]
    v_pk_mul_f32 v[150:151], v[150:151], v[106:107] op_sel:[0,1] op_sel_hi:[1,1]
    v_cvt_pk_bf16_f32 v130, v148, v149
    v_cvt_pk_bf16_f32 v131, v150, v151
    v_lshlrev_b32 v148, 16, v130
    v_and_b32 v149, 4294901760, v130
    v_lshlrev_b32 v150, 16, v131
    v_and_b32 v151, 4294901760, v131
    v_pk_add_f32 v[148:149], v[148:149], v[122:123]
    v_pk_add_f32 v[150:151], v[150:151], v[124:125]
    v_cvt_pk_bf16_f32 v130, v148, v149
    v_cvt_pk_bf16_f32 v131, v150, v151
    v_lshlrev_b32 v148, 16, v130
    v_and_b32 v149, 4294901760, v130
    v_lshlrev_b32 v150, 16, v131
    v_and_b32 v151, 4294901760, v131
    v_pk_mul_f32 v[126:127], v[148:149], v[148:149]
    v_pk_mul_f32 v[128:129], v[150:151], v[150:151]
    v_pk_fma_f32 v[126:127], v[126:127], s[70:71], v[118:119]
    v_pk_fma_f32 v[128:129], v[128:129], s[70:71], v[118:119]
    v_pk_mul_f32 v[126:127], v[126:127], v[148:149]
    v_pk_mul_f32 v[128:129], v[128:129], v[150:151]
    v_exp_f32 v126, v126
    v_exp_f32 v127, v127
    v_exp_f32 v128, v128
    v_exp_f32 v129, v129
    v_pk_add_f32 v[126:127], v[126:127], v[120:121]
    v_pk_add_f32 v[128:129], v[128:129], v[120:121]
    v_rcp_f32 v126, v126
    v_rcp_f32 v127, v127
    v_rcp_f32 v128, v128
    v_rcp_f32 v129, v129
    v_pk_mul_f32 v[148:149], v[148:149], v[126:127]
    v_pk_mul_f32 v[150:151], v[150:151], v[128:129]
    v_cvt_pk_bf16_f32 v132, v148, v149
    v_cvt_pk_bf16_f32 v133, v150, v151
    buffer_store_dwordx2 v[132:133], v9, s[52:55], 0 offen
    v_lshlrev_b32 v122, 16, v14
    v_and_b32 v123, 4294901760, v14
    v_lshlrev_b32 v124, 16, v15
    v_and_b32 v125, 4294901760, v15
    v_pk_fma_f32 v[156:157], v[72:73], v[106:107], v[156:157] op_sel_hi:[1,0,1] neg_lo:[0,1,0] neg_hi:[0,1,0]
    v_pk_fma_f32 v[158:159], v[74:75], v[106:107], v[158:159] op_sel_hi:[1,0,1] neg_lo:[0,1,0] neg_hi:[0,1,0]
    v_pk_mul_f32 v[156:157], v[156:157], v[106:107] op_sel:[0,1] op_sel_hi:[1,1]
    v_pk_mul_f32 v[158:159], v[158:159], v[106:107] op_sel:[0,1] op_sel_hi:[1,1]
    v_cvt_pk_bf16_f32 v130, v156, v157
    v_cvt_pk_bf16_f32 v131, v158, v159
    v_lshlrev_b32 v156, 16, v130
    v_and_b32 v157, 4294901760, v130
    v_lshlrev_b32 v158, 16, v131
    v_and_b32 v159, 4294901760, v131
    v_pk_add_f32 v[156:157], v[156:157], v[122:123]
    v_pk_add_f32 v[158:159], v[158:159], v[124:125]
    v_cvt_pk_bf16_f32 v130, v156, v157
    v_cvt_pk_bf16_f32 v131, v158, v159
    v_lshlrev_b32 v156, 16, v130
    v_and_b32 v157, 4294901760, v130
    v_lshlrev_b32 v158, 16, v131
    v_and_b32 v159, 4294901760, v131
    v_pk_mul_f32 v[126:127], v[156:157], v[156:157]
    v_pk_mul_f32 v[128:129], v[158:159], v[158:159]
    v_pk_fma_f32 v[126:127], v[126:127], s[70:71], v[118:119]
    v_pk_fma_f32 v[128:129], v[128:129], s[70:71], v[118:119]
    v_pk_mul_f32 v[126:127], v[126:127], v[156:157]
    v_pk_mul_f32 v[128:129], v[128:129], v[158:159]
    v_exp_f32 v126, v126
    v_exp_f32 v127, v127
    v_exp_f32 v128, v128
    v_exp_f32 v129, v129
    v_pk_add_f32 v[126:127], v[126:127], v[120:121]
    v_pk_add_f32 v[128:129], v[128:129], v[120:121]
    v_rcp_f32 v126, v126
    v_rcp_f32 v127, v127
    v_rcp_f32 v128, v128
    v_rcp_f32 v129, v129
    v_pk_mul_f32 v[156:157], v[156:157], v[126:127]
    v_pk_mul_f32 v[158:159], v[158:159], v[128:129]
    v_cvt_pk_bf16_f32 v134, v156, v157
    v_cvt_pk_bf16_f32 v135, v158, v159
    buffer_store_dwordx2 v[134:135], v9, s[52:55], 0 offen offset:32
    v_lshlrev_b32 v122, 16, v16
    v_and_b32 v123, 4294901760, v16
    v_lshlrev_b32 v124, 16, v17
    v_and_b32 v125, 4294901760, v17
    v_pk_fma_f32 v[164:165], v[76:77], v[106:107], v[164:165] op_sel_hi:[1,0,1] neg_lo:[0,1,0] neg_hi:[0,1,0]
    v_pk_fma_f32 v[166:167], v[78:79], v[106:107], v[166:167] op_sel_hi:[1,0,1] neg_lo:[0,1,0] neg_hi:[0,1,0]
    v_pk_mul_f32 v[164:165], v[164:165], v[106:107] op_sel:[0,1] op_sel_hi:[1,1]
    v_pk_mul_f32 v[166:167], v[166:167], v[106:107] op_sel:[0,1] op_sel_hi:[1,1]
    v_cvt_pk_bf16_f32 v130, v164, v165
    v_cvt_pk_bf16_f32 v131, v166, v167
    v_lshlrev_b32 v164, 16, v130
    v_and_b32 v165, 4294901760, v130
    v_lshlrev_b32 v166, 16, v131
    v_and_b32 v167, 4294901760, v131
    v_pk_add_f32 v[164:165], v[164:165], v[122:123]
    v_pk_add_f32 v[166:167], v[166:167], v[124:125]
    v_cvt_pk_bf16_f32 v130, v164, v165
    v_cvt_pk_bf16_f32 v131, v166, v167
    v_lshlrev_b32 v164, 16, v130
    v_and_b32 v165, 4294901760, v130
    v_lshlrev_b32 v166, 16, v131
    v_and_b32 v167, 4294901760, v131
    v_pk_mul_f32 v[126:127], v[164:165], v[164:165]
    v_pk_mul_f32 v[128:129], v[166:167], v[166:167]
    v_pk_fma_f32 v[126:127], v[126:127], s[70:71], v[118:119]
    v_pk_fma_f32 v[128:129], v[128:129], s[70:71], v[118:119]
    v_pk_mul_f32 v[126:127], v[126:127], v[164:165]
    v_pk_mul_f32 v[128:129], v[128:129], v[166:167]
    v_exp_f32 v126, v126
    v_exp_f32 v127, v127
    v_exp_f32 v128, v128
    v_exp_f32 v129, v129
    v_pk_add_f32 v[126:127], v[126:127], v[120:121]
    v_pk_add_f32 v[128:129], v[128:129], v[120:121]
    v_rcp_f32 v126, v126
    v_rcp_f32 v127, v127
    v_rcp_f32 v128, v128
    v_rcp_f32 v129, v129
    v_pk_mul_f32 v[164:165], v[164:165], v[126:127]
    v_pk_mul_f32 v[166:167], v[166:167], v[128:129]
    v_cvt_pk_bf16_f32 v132, v164, v165
    v_cvt_pk_bf16_f32 v133, v166, v167
    buffer_store_dwordx2 v[132:133], v9, s[52:55], 0 offen offset:64
    v_lshlrev_b32 v122, 16, v18
    v_and_b32 v123, 4294901760, v18
    v_lshlrev_b32 v124, 16, v19
    v_and_b32 v125, 4294901760, v19
    v_pk_fma_f32 v[172:173], v[80:81], v[106:107], v[172:173] op_sel_hi:[1,0,1] neg_lo:[0,1,0] neg_hi:[0,1,0]
    v_pk_fma_f32 v[174:175], v[82:83], v[106:107], v[174:175] op_sel_hi:[1,0,1] neg_lo:[0,1,0] neg_hi:[0,1,0]
    v_pk_mul_f32 v[172:173], v[172:173], v[106:107] op_sel:[0,1] op_sel_hi:[1,1]
    v_pk_mul_f32 v[174:175], v[174:175], v[106:107] op_sel:[0,1] op_sel_hi:[1,1]
    v_cvt_pk_bf16_f32 v130, v172, v173
    v_cvt_pk_bf16_f32 v131, v174, v175
    v_lshlrev_b32 v172, 16, v130
    v_and_b32 v173, 4294901760, v130
    v_lshlrev_b32 v174, 16, v131
    v_and_b32 v175, 4294901760, v131
    v_pk_add_f32 v[172:173], v[172:173], v[122:123]
    v_pk_add_f32 v[174:175], v[174:175], v[124:125]
    v_cvt_pk_bf16_f32 v130, v172, v173
    v_cvt_pk_bf16_f32 v131, v174, v175
    v_lshlrev_b32 v172, 16, v130
    v_and_b32 v173, 4294901760, v130
    v_lshlrev_b32 v174, 16, v131
    v_and_b32 v175, 4294901760, v131
    v_pk_mul_f32 v[126:127], v[172:173], v[172:173]
    v_pk_mul_f32 v[128:129], v[174:175], v[174:175]
    v_pk_fma_f32 v[126:127], v[126:127], s[70:71], v[118:119]
    v_pk_fma_f32 v[128:129], v[128:129], s[70:71], v[118:119]
    v_pk_mul_f32 v[126:127], v[126:127], v[172:173]
    v_pk_mul_f32 v[128:129], v[128:129], v[174:175]
    v_exp_f32 v126, v126
    v_exp_f32 v127, v127
    v_exp_f32 v128, v128
    v_exp_f32 v129, v129
    v_pk_add_f32 v[126:127], v[126:127], v[120:121]
    v_pk_add_f32 v[128:129], v[128:129], v[120:121]
    v_rcp_f32 v126, v126
    v_rcp_f32 v127, v127
    v_rcp_f32 v128, v128
    v_rcp_f32 v129, v129
    v_pk_mul_f32 v[172:173], v[172:173], v[126:127]
    v_pk_mul_f32 v[174:175], v[174:175], v[128:129]
    v_cvt_pk_bf16_f32 v134, v172, v173
    v_cvt_pk_bf16_f32 v135, v174, v175
    buffer_store_dwordx2 v[134:135], v9, s[52:55], 0 offen offset:96
    v_lshlrev_b32 v122, 16, v20
    v_and_b32 v123, 4294901760, v20
    v_lshlrev_b32 v124, 16, v21
    v_and_b32 v125, 4294901760, v21
    v_pk_fma_f32 v[180:181], v[84:85], v[106:107], v[180:181] op_sel_hi:[1,0,1] neg_lo:[0,1,0] neg_hi:[0,1,0]
    v_pk_fma_f32 v[182:183], v[86:87], v[106:107], v[182:183] op_sel_hi:[1,0,1] neg_lo:[0,1,0] neg_hi:[0,1,0]
    v_pk_mul_f32 v[180:181], v[180:181], v[106:107] op_sel:[0,1] op_sel_hi:[1,1]
    v_pk_mul_f32 v[182:183], v[182:183], v[106:107] op_sel:[0,1] op_sel_hi:[1,1]
    v_cvt_pk_bf16_f32 v130, v180, v181
    v_cvt_pk_bf16_f32 v131, v182, v183
    v_lshlrev_b32 v180, 16, v130
    v_and_b32 v181, 4294901760, v130
    v_lshlrev_b32 v182, 16, v131
    v_and_b32 v183, 4294901760, v131
    v_pk_add_f32 v[180:181], v[180:181], v[122:123]
    v_pk_add_f32 v[182:183], v[182:183], v[124:125]
    v_cvt_pk_bf16_f32 v130, v180, v181
    v_cvt_pk_bf16_f32 v131, v182, v183
    v_lshlrev_b32 v180, 16, v130
    v_and_b32 v181, 4294901760, v130
    v_lshlrev_b32 v182, 16, v131
    v_and_b32 v183, 4294901760, v131
    v_pk_mul_f32 v[126:127], v[180:181], v[180:181]
    v_pk_mul_f32 v[128:129], v[182:183], v[182:183]
    v_pk_fma_f32 v[126:127], v[126:127], s[70:71], v[118:119]
    v_pk_fma_f32 v[128:129], v[128:129], s[70:71], v[118:119]
    v_pk_mul_f32 v[126:127], v[126:127], v[180:181]
    v_pk_mul_f32 v[128:129], v[128:129], v[182:183]
    v_exp_f32 v126, v126
    v_exp_f32 v127, v127
    v_exp_f32 v128, v128
    v_exp_f32 v129, v129
    v_pk_add_f32 v[126:127], v[126:127], v[120:121]
    v_pk_add_f32 v[128:129], v[128:129], v[120:121]
    v_rcp_f32 v126, v126
    v_rcp_f32 v127, v127
    v_rcp_f32 v128, v128
    v_rcp_f32 v129, v129
    v_pk_mul_f32 v[180:181], v[180:181], v[126:127]
    v_pk_mul_f32 v[182:183], v[182:183], v[128:129]
    v_cvt_pk_bf16_f32 v132, v180, v181
    v_cvt_pk_bf16_f32 v133, v182, v183
    buffer_store_dwordx2 v[132:133], v9, s[52:55], 0 offen offset:128
    v_lshlrev_b32 v122, 16, v22
    v_and_b32 v123, 4294901760, v22
    v_lshlrev_b32 v124, 16, v23
    v_and_b32 v125, 4294901760, v23
    v_pk_fma_f32 v[188:189], v[88:89], v[106:107], v[188:189] op_sel_hi:[1,0,1] neg_lo:[0,1,0] neg_hi:[0,1,0]
    v_pk_fma_f32 v[190:191], v[90:91], v[106:107], v[190:191] op_sel_hi:[1,0,1] neg_lo:[0,1,0] neg_hi:[0,1,0]
    v_pk_mul_f32 v[188:189], v[188:189], v[106:107] op_sel:[0,1] op_sel_hi:[1,1]
    v_pk_mul_f32 v[190:191], v[190:191], v[106:107] op_sel:[0,1] op_sel_hi:[1,1]
    v_cvt_pk_bf16_f32 v130, v188, v189
    v_cvt_pk_bf16_f32 v131, v190, v191
    v_lshlrev_b32 v188, 16, v130
    v_and_b32 v189, 4294901760, v130
    v_lshlrev_b32 v190, 16, v131
    v_and_b32 v191, 4294901760, v131
    v_pk_add_f32 v[188:189], v[188:189], v[122:123]
    v_pk_add_f32 v[190:191], v[190:191], v[124:125]
    v_cvt_pk_bf16_f32 v130, v188, v189
    v_cvt_pk_bf16_f32 v131, v190, v191
    v_lshlrev_b32 v188, 16, v130
    v_and_b32 v189, 4294901760, v130
    v_lshlrev_b32 v190, 16, v131
    v_and_b32 v191, 4294901760, v131
    v_pk_mul_f32 v[126:127], v[188:189], v[188:189]
    v_pk_mul_f32 v[128:129], v[190:191], v[190:191]
    v_pk_fma_f32 v[126:127], v[126:127], s[70:71], v[118:119]
    v_pk_fma_f32 v[128:129], v[128:129], s[70:71], v[118:119]
    v_pk_mul_f32 v[126:127], v[126:127], v[188:189]
    v_pk_mul_f32 v[128:129], v[128:129], v[190:191]
    v_exp_f32 v126, v126
    v_exp_f32 v127, v127
    v_exp_f32 v128, v128
    v_exp_f32 v129, v129
    v_pk_add_f32 v[126:127], v[126:127], v[120:121]
    v_pk_add_f32 v[128:129], v[128:129], v[120:121]
    v_rcp_f32 v126, v126
    v_rcp_f32 v127, v127
    v_rcp_f32 v128, v128
    v_rcp_f32 v129, v129
    v_pk_mul_f32 v[188:189], v[188:189], v[126:127]
    v_pk_mul_f32 v[190:191], v[190:191], v[128:129]
    v_cvt_pk_bf16_f32 v134, v188, v189
    v_cvt_pk_bf16_f32 v135, v190, v191
    buffer_store_dwordx2 v[134:135], v9, s[52:55], 0 offen offset:160
    v_lshlrev_b32 v122, 16, v24
    v_and_b32 v123, 4294901760, v24
    v_lshlrev_b32 v124, 16, v25
    v_and_b32 v125, 4294901760, v25
    v_pk_fma_f32 v[196:197], v[92:93], v[106:107], v[196:197] op_sel_hi:[1,0,1] neg_lo:[0,1,0] neg_hi:[0,1,0]
    v_pk_fma_f32 v[198:199], v[94:95], v[106:107], v[198:199] op_sel_hi:[1,0,1] neg_lo:[0,1,0] neg_hi:[0,1,0]
    v_pk_mul_f32 v[196:197], v[196:197], v[106:107] op_sel:[0,1] op_sel_hi:[1,1]
    v_pk_mul_f32 v[198:199], v[198:199], v[106:107] op_sel:[0,1] op_sel_hi:[1,1]
    v_cvt_pk_bf16_f32 v130, v196, v197
    v_cvt_pk_bf16_f32 v131, v198, v199
    v_lshlrev_b32 v196, 16, v130
    v_and_b32 v197, 4294901760, v130
    v_lshlrev_b32 v198, 16, v131
    v_and_b32 v199, 4294901760, v131
    v_pk_add_f32 v[196:197], v[196:197], v[122:123]
    v_pk_add_f32 v[198:199], v[198:199], v[124:125]
    v_cvt_pk_bf16_f32 v130, v196, v197
    v_cvt_pk_bf16_f32 v131, v198, v199
    v_lshlrev_b32 v196, 16, v130
    v_and_b32 v197, 4294901760, v130
    v_lshlrev_b32 v198, 16, v131
    v_and_b32 v199, 4294901760, v131
    v_pk_mul_f32 v[126:127], v[196:197], v[196:197]
    v_pk_mul_f32 v[128:129], v[198:199], v[198:199]
    v_pk_fma_f32 v[126:127], v[126:127], s[70:71], v[118:119]
    v_pk_fma_f32 v[128:129], v[128:129], s[70:71], v[118:119]
    v_pk_mul_f32 v[126:127], v[126:127], v[196:197]
    v_pk_mul_f32 v[128:129], v[128:129], v[198:199]
    v_exp_f32 v126, v126
    v_exp_f32 v127, v127
    v_exp_f32 v128, v128
    v_exp_f32 v129, v129
    v_pk_add_f32 v[126:127], v[126:127], v[120:121]
    v_pk_add_f32 v[128:129], v[128:129], v[120:121]
    v_rcp_f32 v126, v126
    v_rcp_f32 v127, v127
    v_rcp_f32 v128, v128
    v_rcp_f32 v129, v129
    v_pk_mul_f32 v[196:197], v[196:197], v[126:127]
    v_pk_mul_f32 v[198:199], v[198:199], v[128:129]
    v_cvt_pk_bf16_f32 v132, v196, v197
    v_cvt_pk_bf16_f32 v133, v198, v199
    buffer_store_dwordx2 v[132:133], v9, s[52:55], 0 offen offset:192
    s_endpgm
L_sequential_preLN__sliding_local_dilated__mixer_channel_mlp__prompt_k3_kernel_loader:
    s_sub_u32 s58, s3, 4
    v_lshrrev_b32 v26, 3, v1
    v_and_b32 v27, 7, v1
    v_xor_b32 v28, v27, v26
    v_lshlrev_b32 v28, 4, v28
    s_lshl_b32 s63, s56, 7
    s_lshl_b32 s64, s58, 5
    s_add_u32 s63, s63, s64
    v_add_u32 v29, s63, v26
    v_lshl_add_u32 v31, v29, 10, v28
    s_lshl_b32 s65, s58, 12
    s_mov_b32 s66, 3584
    v_lshrrev_b32 v29, 4, v1
    v_lshlrev_b32 v30, 1, v29
    v_and_b32 v28, 15, v1
    v_xor_b32 v30, v30, v28
    v_min_u32 v30, 13, v30
    v_lshlrev_b32 v30, 4, v30
    s_lshl_b32 s63, s58, 4
    v_add_u32 v29, s63, v29
    v_mul_lo_u32 v29, v29, s66
    v_add_u32 v29, v29, v30
    s_mul_i32 s63, s57, 224
    v_add_u32 v32, s63, v29
    v_lshrrev_b32 v29, 4, v1
    v_lshlrev_b32 v30, 1, v29
    v_or_b32 v30, 8, v30
    v_and_b32 v28, 15, v1
    v_xor_b32 v30, v30, v28
    v_min_u32 v30, 13, v30
    v_lshlrev_b32 v30, 4, v30
    s_lshl_b32 s63, s58, 4
    v_add_u32 v29, s63, v29
    v_mul_lo_u32 v29, v29, s66
    v_add_u32 v29, v29, v30
    s_mul_i32 s63, s57, 224
    v_add_u32 v33, s63, v29
    s_waitcnt lgkmcnt(0)
    s_add_u32 s36, s34, 2097152
    s_addc_u32 s37, s35, 0
    s_and_b32 s37, s37, 65535
    s_mov_b32 s38, 2097152
    s_mov_b32 s39, 131072
    s_mov_b32 s40, s24
    s_and_b32 s41, s25, 65535
    s_mov_b32 s42, 1835008
    s_mov_b32 s43, 131072
    s_mov_b32 s44, s26
    s_and_b32 s45, s27, 65535
    s_mov_b32 s46, 3584
    s_mov_b32 s47, 131072
    s_add_u32 s52, s34, 4194304
    s_addc_u32 s53, s35, 0
    s_and_b32 s53, s53, 65535
    s_mov_b32 s54, 7340032
    s_mov_b32 s55, 131072
    buffer_load_dwordx2 v[12:13], v8, s[44:47], 0 offen
    buffer_load_dwordx2 v[14:15], v8, s[44:47], 0 offen offset:32
    buffer_load_dwordx2 v[16:17], v8, s[44:47], 0 offen offset:64
    buffer_load_dwordx2 v[18:19], v8, s[44:47], 0 offen offset:96
    buffer_load_dwordx2 v[20:21], v8, s[44:47], 0 offen offset:128
    buffer_load_dwordx2 v[22:23], v8, s[44:47], 0 offen offset:160
    buffer_load_dwordx2 v[24:25], v8, s[44:47], 0 offen offset:192
    s_and_b32 s68, s2, 7
    s_mul_i32 s68, s68, 8
    s_lshr_b32 s68, s68, 3
    s_add_u32 m0, s65, 16384
    s_mul_i32 s67, s68, 229376
    buffer_load_dwordx4 v32, s[40:43], s67 offen lds
    s_add_u32 m0, s65, 17408
    s_mul_i32 s67, s68, 229376
    s_add_u32 s67, s67, 14336
    buffer_load_dwordx4 v32, s[40:43], s67 offen lds
    s_add_u32 m0, s65, 18432
    s_mul_i32 s67, s68, 229376
    s_add_u32 s67, s67, 28672
    buffer_load_dwordx4 v33, s[40:43], s67 offen lds
    s_add_u32 m0, s65, 19456
    s_mul_i32 s67, s68, 229376
    s_add_u32 s67, s67, 43008
    buffer_load_dwordx4 v33, s[40:43], s67 offen lds
    s_add_u32 m0, s65, 0
    s_lshl_b32 s67, s68, 7
    buffer_load_dwordx4 v31, s[36:39], s67 offen lds
    s_add_u32 m0, s65, 1024
    s_lshl_b32 s67, s68, 7
    s_add_u32 s67, s67, 8192
    buffer_load_dwordx4 v31, s[36:39], s67 offen lds
    s_add_u32 m0, s65, 2048
    s_lshl_b32 s67, s68, 7
    s_add_u32 s67, s67, 16384
    buffer_load_dwordx4 v31, s[36:39], s67 offen lds
    s_add_u32 m0, s65, 3072
    s_lshl_b32 s67, s68, 7
    s_add_u32 s67, s67, 24576
    buffer_load_dwordx4 v31, s[36:39], s67 offen lds
    s_add_u32 s68, s68, 1
    s_cmp_ge_u32 s68, 8
    s_cselect_b32 s68, 0, s68
    s_add_u32 m0, s65, 49152
    s_mul_i32 s67, s68, 229376
    buffer_load_dwordx4 v32, s[40:43], s67 offen lds
    s_add_u32 m0, s65, 50176
    s_mul_i32 s67, s68, 229376
    s_add_u32 s67, s67, 14336
    buffer_load_dwordx4 v32, s[40:43], s67 offen lds
    s_add_u32 m0, s65, 51200
    s_mul_i32 s67, s68, 229376
    s_add_u32 s67, s67, 28672
    buffer_load_dwordx4 v33, s[40:43], s67 offen lds
    s_add_u32 m0, s65, 52224
    s_mul_i32 s67, s68, 229376
    s_add_u32 s67, s67, 43008
    buffer_load_dwordx4 v33, s[40:43], s67 offen lds
    s_add_u32 m0, s65, 32768
    s_lshl_b32 s67, s68, 7
    buffer_load_dwordx4 v31, s[36:39], s67 offen lds
    s_add_u32 m0, s65, 33792
    s_lshl_b32 s67, s68, 7
    s_add_u32 s67, s67, 8192
    buffer_load_dwordx4 v31, s[36:39], s67 offen lds
    s_add_u32 m0, s65, 34816
    s_lshl_b32 s67, s68, 7
    s_add_u32 s67, s67, 16384
    buffer_load_dwordx4 v31, s[36:39], s67 offen lds
    s_add_u32 m0, s65, 35840
    s_lshl_b32 s67, s68, 7
    s_add_u32 s67, s67, 24576
    buffer_load_dwordx4 v31, s[36:39], s67 offen lds
    s_add_u32 s68, s68, 1
    s_cmp_ge_u32 s68, 8
    s_cselect_b32 s68, 0, s68
    s_waitcnt vmcnt(8)
    s_barrier
    s_add_u32 m0, s65, 81920
    s_mul_i32 s67, s68, 229376
    buffer_load_dwordx4 v32, s[40:43], s67 offen lds
    s_add_u32 m0, s65, 82944
    s_mul_i32 s67, s68, 229376
    s_add_u32 s67, s67, 14336
    buffer_load_dwordx4 v32, s[40:43], s67 offen lds
    s_add_u32 m0, s65, 83968
    s_mul_i32 s67, s68, 229376
    s_add_u32 s67, s67, 28672
    buffer_load_dwordx4 v33, s[40:43], s67 offen lds
    s_add_u32 m0, s65, 84992
    s_mul_i32 s67, s68, 229376
    s_add_u32 s67, s67, 43008
    buffer_load_dwordx4 v33, s[40:43], s67 offen lds
    s_add_u32 m0, s65, 65536
    s_lshl_b32 s67, s68, 7
    buffer_load_dwordx4 v31, s[36:39], s67 offen lds
    s_add_u32 m0, s65, 66560
    s_lshl_b32 s67, s68, 7
    s_add_u32 s67, s67, 8192
    buffer_load_dwordx4 v31, s[36:39], s67 offen lds
    s_add_u32 m0, s65, 67584
    s_lshl_b32 s67, s68, 7
    s_add_u32 s67, s67, 16384
    buffer_load_dwordx4 v31, s[36:39], s67 offen lds
    s_add_u32 m0, s65, 68608
    s_lshl_b32 s67, s68, 7
    s_add_u32 s67, s67, 24576
    buffer_load_dwordx4 v31, s[36:39], s67 offen lds
    s_add_u32 s68, s68, 1
    s_cmp_ge_u32 s68, 8
    s_cselect_b32 s68, 0, s68
    s_add_u32 m0, s65, 114688
    s_mul_i32 s67, s68, 229376
    buffer_load_dwordx4 v32, s[40:43], s67 offen lds
    s_add_u32 m0, s65, 115712
    s_mul_i32 s67, s68, 229376
    s_add_u32 s67, s67, 14336
    buffer_load_dwordx4 v32, s[40:43], s67 offen lds
    s_add_u32 m0, s65, 116736
    s_mul_i32 s67, s68, 229376
    s_add_u32 s67, s67, 28672
    buffer_load_dwordx4 v33, s[40:43], s67 offen lds
    s_add_u32 m0, s65, 117760
    s_mul_i32 s67, s68, 229376
    s_add_u32 s67, s67, 43008
    buffer_load_dwordx4 v33, s[40:43], s67 offen lds
    s_add_u32 m0, s65, 98304
    s_lshl_b32 s67, s68, 7
    buffer_load_dwordx4 v31, s[36:39], s67 offen lds
    s_add_u32 m0, s65, 99328
    s_lshl_b32 s67, s68, 7
    s_add_u32 s67, s67, 8192
    buffer_load_dwordx4 v31, s[36:39], s67 offen lds
    s_add_u32 m0, s65, 100352
    s_lshl_b32 s67, s68, 7
    s_add_u32 s67, s67, 16384
    buffer_load_dwordx4 v31, s[36:39], s67 offen lds
    s_add_u32 m0, s65, 101376
    s_lshl_b32 s67, s68, 7
    s_add_u32 s67, s67, 24576
    buffer_load_dwordx4 v31, s[36:39], s67 offen lds
    s_add_u32 s68, s68, 1
    s_cmp_ge_u32 s68, 8
    s_cselect_b32 s68, 0, s68
    s_waitcnt vmcnt(16)
    s_barrier
    s_add_u32 m0, s65, 16384
    s_mul_i32 s67, s68, 229376
    buffer_load_dwordx4 v32, s[40:43], s67 offen lds
    s_add_u32 m0, s65, 17408
    s_mul_i32 s67, s68, 229376
    s_add_u32 s67, s67, 14336
    buffer_load_dwordx4 v32, s[40:43], s67 offen lds
    s_add_u32 m0, s65, 18432
    s_mul_i32 s67, s68, 229376
    s_add_u32 s67, s67, 28672
    buffer_load_dwordx4 v33, s[40:43], s67 offen lds
    s_add_u32 m0, s65, 19456
    s_mul_i32 s67, s68, 229376
    s_add_u32 s67, s67, 43008
    buffer_load_dwordx4 v33, s[40:43], s67 offen lds
    s_add_u32 m0, s65, 0
    s_lshl_b32 s67, s68, 7
    buffer_load_dwordx4 v31, s[36:39], s67 offen lds
    s_add_u32 m0, s65, 1024
    s_lshl_b32 s67, s68, 7
    s_add_u32 s67, s67, 8192
    buffer_load_dwordx4 v31, s[36:39], s67 offen lds
    s_add_u32 m0, s65, 2048
    s_lshl_b32 s67, s68, 7
    s_add_u32 s67, s67, 16384
    buffer_load_dwordx4 v31, s[36:39], s67 offen lds
    s_add_u32 m0, s65, 3072
    s_lshl_b32 s67, s68, 7
    s_add_u32 s67, s67, 24576
    buffer_load_dwordx4 v31, s[36:39], s67 offen lds
    s_add_u32 s68, s68, 1
    s_cmp_ge_u32 s68, 8
    s_cselect_b32 s68, 0, s68
    s_waitcnt vmcnt(16)
    s_barrier
    s_add_u32 m0, s65, 49152
    s_mul_i32 s67, s68, 229376
    buffer_load_dwordx4 v32, s[40:43], s67 offen lds
    s_add_u32 m0, s65, 50176
    s_mul_i32 s67, s68, 229376
    s_add_u32 s67, s67, 14336
    buffer_load_dwordx4 v32, s[40:43], s67 offen lds
    s_add_u32 m0, s65, 51200
    s_mul_i32 s67, s68, 229376
    s_add_u32 s67, s67, 28672
    buffer_load_dwordx4 v33, s[40:43], s67 offen lds
    s_add_u32 m0, s65, 52224
    s_mul_i32 s67, s68, 229376
    s_add_u32 s67, s67, 43008
    buffer_load_dwordx4 v33, s[40:43], s67 offen lds
    s_add_u32 m0, s65, 32768
    s_lshl_b32 s67, s68, 7
    buffer_load_dwordx4 v31, s[36:39], s67 offen lds
    s_add_u32 m0, s65, 33792
    s_lshl_b32 s67, s68, 7
    s_add_u32 s67, s67, 8192
    buffer_load_dwordx4 v31, s[36:39], s67 offen lds
    s_add_u32 m0, s65, 34816
    s_lshl_b32 s67, s68, 7
    s_add_u32 s67, s67, 16384
    buffer_load_dwordx4 v31, s[36:39], s67 offen lds
    s_add_u32 m0, s65, 35840
    s_lshl_b32 s67, s68, 7
    s_add_u32 s67, s67, 24576
    buffer_load_dwordx4 v31, s[36:39], s67 offen lds
    s_add_u32 s68, s68, 1
    s_cmp_ge_u32 s68, 8
    s_cselect_b32 s68, 0, s68
    s_waitcnt vmcnt(16)
    s_barrier
    s_add_u32 m0, s65, 81920
    s_mul_i32 s67, s68, 229376
    buffer_load_dwordx4 v32, s[40:43], s67 offen lds
    s_add_u32 m0, s65, 82944
    s_mul_i32 s67, s68, 229376
    s_add_u32 s67, s67, 14336
    buffer_load_dwordx4 v32, s[40:43], s67 offen lds
    s_add_u32 m0, s65, 83968
    s_mul_i32 s67, s68, 229376
    s_add_u32 s67, s67, 28672
    buffer_load_dwordx4 v33, s[40:43], s67 offen lds
    s_add_u32 m0, s65, 84992
    s_mul_i32 s67, s68, 229376
    s_add_u32 s67, s67, 43008
    buffer_load_dwordx4 v33, s[40:43], s67 offen lds
    s_add_u32 m0, s65, 65536
    s_lshl_b32 s67, s68, 7
    buffer_load_dwordx4 v31, s[36:39], s67 offen lds
    s_add_u32 m0, s65, 66560
    s_lshl_b32 s67, s68, 7
    s_add_u32 s67, s67, 8192
    buffer_load_dwordx4 v31, s[36:39], s67 offen lds
    s_add_u32 m0, s65, 67584
    s_lshl_b32 s67, s68, 7
    s_add_u32 s67, s67, 16384
    buffer_load_dwordx4 v31, s[36:39], s67 offen lds
    s_add_u32 m0, s65, 68608
    s_lshl_b32 s67, s68, 7
    s_add_u32 s67, s67, 24576
    buffer_load_dwordx4 v31, s[36:39], s67 offen lds
    s_add_u32 s68, s68, 1
    s_cmp_ge_u32 s68, 8
    s_cselect_b32 s68, 0, s68
    s_waitcnt vmcnt(16)
    s_barrier
    s_add_u32 m0, s65, 114688
    s_mul_i32 s67, s68, 229376
    buffer_load_dwordx4 v32, s[40:43], s67 offen lds
    s_add_u32 m0, s65, 115712
    s_mul_i32 s67, s68, 229376
    s_add_u32 s67, s67, 14336
    buffer_load_dwordx4 v32, s[40:43], s67 offen lds
    s_add_u32 m0, s65, 116736
    s_mul_i32 s67, s68, 229376
    s_add_u32 s67, s67, 28672
    buffer_load_dwordx4 v33, s[40:43], s67 offen lds
    s_add_u32 m0, s65, 117760
    s_mul_i32 s67, s68, 229376
    s_add_u32 s67, s67, 43008
    buffer_load_dwordx4 v33, s[40:43], s67 offen lds
    s_add_u32 m0, s65, 98304
    s_lshl_b32 s67, s68, 7
    buffer_load_dwordx4 v31, s[36:39], s67 offen lds
    s_add_u32 m0, s65, 99328
    s_lshl_b32 s67, s68, 7
    s_add_u32 s67, s67, 8192
    buffer_load_dwordx4 v31, s[36:39], s67 offen lds
    s_add_u32 m0, s65, 100352
    s_lshl_b32 s67, s68, 7
    s_add_u32 s67, s67, 16384
    buffer_load_dwordx4 v31, s[36:39], s67 offen lds
    s_add_u32 m0, s65, 101376
    s_lshl_b32 s67, s68, 7
    s_add_u32 s67, s67, 24576
    buffer_load_dwordx4 v31, s[36:39], s67 offen lds
    s_add_u32 s68, s68, 1
    s_cmp_ge_u32 s68, 8
    s_cselect_b32 s68, 0, s68
    s_waitcnt vmcnt(16)
    s_barrier
    s_waitcnt vmcnt(8)
    s_barrier
    s_waitcnt vmcnt(0)
    s_barrier
    s_barrier
    ds_read_b128 v[36:39], v11
    ds_read_b128 v[40:43], v11 offset:1024
    ds_read_b128 v[44:47], v11 offset:2048
    ds_read_b128 v[48:51], v11 offset:3072
    ds_read_b128 v[52:55], v11 offset:4096
    ds_read_b128 v[56:59], v11 offset:5120
    ds_read_b128 v[60:63], v11 offset:6144
    ds_read_b64 v[92:93], v11 offset:7168
    ds_read_b128 v[64:67], v10
    ds_read_b128 v[68:71], v10 offset:64
    ds_read_b128 v[72:75], v10 offset:128
    ds_read_b128 v[76:79], v10 offset:192
    ds_read_b128 v[80:83], v10 offset:256
    ds_read_b128 v[84:87], v10 offset:320
    ds_read_b128 v[88:91], v10 offset:384
    s_mov_b32 s69, 57344
    s_waitcnt lgkmcnt(0)
    v_mov_b32 v94, 0xc0135761
    v_mov_b32 v96, 1.0
    s_mov_b32 s70, 0xbdd2d3e8
    v_mov_b32 v95, 0xc0135761
    v_mov_b32 v97, 1.0
    s_mov_b32 s71, 0xbdd2d3e8
    v_lshlrev_b32 v98, 16, v12
    v_and_b32 v99, 4294901760, v12
    v_lshlrev_b32 v100, 16, v13
    v_and_b32 v101, 4294901760, v13
    v_pk_fma_f32 v[36:37], v[64:65], v[92:93], v[36:37] op_sel_hi:[1,0,1] neg_lo:[0,1,0] neg_hi:[0,1,0]
    v_pk_fma_f32 v[38:39], v[66:67], v[92:93], v[38:39] op_sel_hi:[1,0,1] neg_lo:[0,1,0] neg_hi:[0,1,0]
    v_pk_mul_f32 v[36:37], v[36:37], v[92:93] op_sel:[0,1] op_sel_hi:[1,1]
    v_pk_mul_f32 v[38:39], v[38:39], v[92:93] op_sel:[0,1] op_sel_hi:[1,1]
    v_cvt_pk_bf16_f32 v106, v36, v37
    v_cvt_pk_bf16_f32 v107, v38, v39
    v_lshlrev_b32 v36, 16, v106
    v_and_b32 v37, 4294901760, v106
    v_lshlrev_b32 v38, 16, v107
    v_and_b32 v39, 4294901760, v107
    v_pk_add_f32 v[36:37], v[36:37], v[98:99]
    v_pk_add_f32 v[38:39], v[38:39], v[100:101]
    v_cvt_pk_bf16_f32 v106, v36, v37
    v_cvt_pk_bf16_f32 v107, v38, v39
    v_lshlrev_b32 v36, 16, v106
    v_and_b32 v37, 4294901760, v106
    v_lshlrev_b32 v38, 16, v107
    v_and_b32 v39, 4294901760, v107
    v_pk_mul_f32 v[102:103], v[36:37], v[36:37]
    v_pk_mul_f32 v[104:105], v[38:39], v[38:39]
    v_pk_fma_f32 v[102:103], v[102:103], s[70:71], v[94:95]
    v_pk_fma_f32 v[104:105], v[104:105], s[70:71], v[94:95]
    v_pk_mul_f32 v[102:103], v[102:103], v[36:37]
    v_pk_mul_f32 v[104:105], v[104:105], v[38:39]
    v_exp_f32 v102, v102
    v_exp_f32 v103, v103
    v_exp_f32 v104, v104
    v_exp_f32 v105, v105
    v_pk_add_f32 v[102:103], v[102:103], v[96:97]
    v_pk_add_f32 v[104:105], v[104:105], v[96:97]
    v_rcp_f32 v102, v102
    v_rcp_f32 v103, v103
    v_rcp_f32 v104, v104
    v_rcp_f32 v105, v105
    v_pk_mul_f32 v[36:37], v[36:37], v[102:103]
    v_pk_mul_f32 v[38:39], v[38:39], v[104:105]
    v_cvt_pk_bf16_f32 v108, v36, v37
    v_cvt_pk_bf16_f32 v109, v38, v39
    buffer_store_dwordx2 v[108:109], v9, s[52:55], s69 offen
    v_lshlrev_b32 v98, 16, v14
    v_and_b32 v99, 4294901760, v14
    v_lshlrev_b32 v100, 16, v15
    v_and_b32 v101, 4294901760, v15
    v_pk_fma_f32 v[40:41], v[68:69], v[92:93], v[40:41] op_sel_hi:[1,0,1] neg_lo:[0,1,0] neg_hi:[0,1,0]
    v_pk_fma_f32 v[42:43], v[70:71], v[92:93], v[42:43] op_sel_hi:[1,0,1] neg_lo:[0,1,0] neg_hi:[0,1,0]
    v_pk_mul_f32 v[40:41], v[40:41], v[92:93] op_sel:[0,1] op_sel_hi:[1,1]
    v_pk_mul_f32 v[42:43], v[42:43], v[92:93] op_sel:[0,1] op_sel_hi:[1,1]
    v_cvt_pk_bf16_f32 v106, v40, v41
    v_cvt_pk_bf16_f32 v107, v42, v43
    v_lshlrev_b32 v40, 16, v106
    v_and_b32 v41, 4294901760, v106
    v_lshlrev_b32 v42, 16, v107
    v_and_b32 v43, 4294901760, v107
    v_pk_add_f32 v[40:41], v[40:41], v[98:99]
    v_pk_add_f32 v[42:43], v[42:43], v[100:101]
    v_cvt_pk_bf16_f32 v106, v40, v41
    v_cvt_pk_bf16_f32 v107, v42, v43
    v_lshlrev_b32 v40, 16, v106
    v_and_b32 v41, 4294901760, v106
    v_lshlrev_b32 v42, 16, v107
    v_and_b32 v43, 4294901760, v107
    v_pk_mul_f32 v[102:103], v[40:41], v[40:41]
    v_pk_mul_f32 v[104:105], v[42:43], v[42:43]
    v_pk_fma_f32 v[102:103], v[102:103], s[70:71], v[94:95]
    v_pk_fma_f32 v[104:105], v[104:105], s[70:71], v[94:95]
    v_pk_mul_f32 v[102:103], v[102:103], v[40:41]
    v_pk_mul_f32 v[104:105], v[104:105], v[42:43]
    v_exp_f32 v102, v102
    v_exp_f32 v103, v103
    v_exp_f32 v104, v104
    v_exp_f32 v105, v105
    v_pk_add_f32 v[102:103], v[102:103], v[96:97]
    v_pk_add_f32 v[104:105], v[104:105], v[96:97]
    v_rcp_f32 v102, v102
    v_rcp_f32 v103, v103
    v_rcp_f32 v104, v104
    v_rcp_f32 v105, v105
    v_pk_mul_f32 v[40:41], v[40:41], v[102:103]
    v_pk_mul_f32 v[42:43], v[42:43], v[104:105]
    v_cvt_pk_bf16_f32 v110, v40, v41
    v_cvt_pk_bf16_f32 v111, v42, v43
    buffer_store_dwordx2 v[110:111], v9, s[52:55], s69 offen offset:32
    v_lshlrev_b32 v98, 16, v16
    v_and_b32 v99, 4294901760, v16
    v_lshlrev_b32 v100, 16, v17
    v_and_b32 v101, 4294901760, v17
    v_pk_fma_f32 v[44:45], v[72:73], v[92:93], v[44:45] op_sel_hi:[1,0,1] neg_lo:[0,1,0] neg_hi:[0,1,0]
    v_pk_fma_f32 v[46:47], v[74:75], v[92:93], v[46:47] op_sel_hi:[1,0,1] neg_lo:[0,1,0] neg_hi:[0,1,0]
    v_pk_mul_f32 v[44:45], v[44:45], v[92:93] op_sel:[0,1] op_sel_hi:[1,1]
    v_pk_mul_f32 v[46:47], v[46:47], v[92:93] op_sel:[0,1] op_sel_hi:[1,1]
    v_cvt_pk_bf16_f32 v106, v44, v45
    v_cvt_pk_bf16_f32 v107, v46, v47
    v_lshlrev_b32 v44, 16, v106
    v_and_b32 v45, 4294901760, v106
    v_lshlrev_b32 v46, 16, v107
    v_and_b32 v47, 4294901760, v107
    v_pk_add_f32 v[44:45], v[44:45], v[98:99]
    v_pk_add_f32 v[46:47], v[46:47], v[100:101]
    v_cvt_pk_bf16_f32 v106, v44, v45
    v_cvt_pk_bf16_f32 v107, v46, v47
    v_lshlrev_b32 v44, 16, v106
    v_and_b32 v45, 4294901760, v106
    v_lshlrev_b32 v46, 16, v107
    v_and_b32 v47, 4294901760, v107
    v_pk_mul_f32 v[102:103], v[44:45], v[44:45]
    v_pk_mul_f32 v[104:105], v[46:47], v[46:47]
    v_pk_fma_f32 v[102:103], v[102:103], s[70:71], v[94:95]
    v_pk_fma_f32 v[104:105], v[104:105], s[70:71], v[94:95]
    v_pk_mul_f32 v[102:103], v[102:103], v[44:45]
    v_pk_mul_f32 v[104:105], v[104:105], v[46:47]
    v_exp_f32 v102, v102
    v_exp_f32 v103, v103
    v_exp_f32 v104, v104
    v_exp_f32 v105, v105
    v_pk_add_f32 v[102:103], v[102:103], v[96:97]
    v_pk_add_f32 v[104:105], v[104:105], v[96:97]
    v_rcp_f32 v102, v102
    v_rcp_f32 v103, v103
    v_rcp_f32 v104, v104
    v_rcp_f32 v105, v105
    v_pk_mul_f32 v[44:45], v[44:45], v[102:103]
    v_pk_mul_f32 v[46:47], v[46:47], v[104:105]
    v_cvt_pk_bf16_f32 v108, v44, v45
    v_cvt_pk_bf16_f32 v109, v46, v47
    buffer_store_dwordx2 v[108:109], v9, s[52:55], s69 offen offset:64
    v_lshlrev_b32 v98, 16, v18
    v_and_b32 v99, 4294901760, v18
    v_lshlrev_b32 v100, 16, v19
    v_and_b32 v101, 4294901760, v19
    v_pk_fma_f32 v[48:49], v[76:77], v[92:93], v[48:49] op_sel_hi:[1,0,1] neg_lo:[0,1,0] neg_hi:[0,1,0]
    v_pk_fma_f32 v[50:51], v[78:79], v[92:93], v[50:51] op_sel_hi:[1,0,1] neg_lo:[0,1,0] neg_hi:[0,1,0]
    v_pk_mul_f32 v[48:49], v[48:49], v[92:93] op_sel:[0,1] op_sel_hi:[1,1]
    v_pk_mul_f32 v[50:51], v[50:51], v[92:93] op_sel:[0,1] op_sel_hi:[1,1]
    v_cvt_pk_bf16_f32 v106, v48, v49
    v_cvt_pk_bf16_f32 v107, v50, v51
    v_lshlrev_b32 v48, 16, v106
    v_and_b32 v49, 4294901760, v106
    v_lshlrev_b32 v50, 16, v107
    v_and_b32 v51, 4294901760, v107
    v_pk_add_f32 v[48:49], v[48:49], v[98:99]
    v_pk_add_f32 v[50:51], v[50:51], v[100:101]
    v_cvt_pk_bf16_f32 v106, v48, v49
    v_cvt_pk_bf16_f32 v107, v50, v51
    v_lshlrev_b32 v48, 16, v106
    v_and_b32 v49, 4294901760, v106
    v_lshlrev_b32 v50, 16, v107
    v_and_b32 v51, 4294901760, v107
    v_pk_mul_f32 v[102:103], v[48:49], v[48:49]
    v_pk_mul_f32 v[104:105], v[50:51], v[50:51]
    v_pk_fma_f32 v[102:103], v[102:103], s[70:71], v[94:95]
    v_pk_fma_f32 v[104:105], v[104:105], s[70:71], v[94:95]
    v_pk_mul_f32 v[102:103], v[102:103], v[48:49]
    v_pk_mul_f32 v[104:105], v[104:105], v[50:51]
    v_exp_f32 v102, v102
    v_exp_f32 v103, v103
    v_exp_f32 v104, v104
    v_exp_f32 v105, v105
    v_pk_add_f32 v[102:103], v[102:103], v[96:97]
    v_pk_add_f32 v[104:105], v[104:105], v[96:97]
    v_rcp_f32 v102, v102
    v_rcp_f32 v103, v103
    v_rcp_f32 v104, v104
    v_rcp_f32 v105, v105
    v_pk_mul_f32 v[48:49], v[48:49], v[102:103]
    v_pk_mul_f32 v[50:51], v[50:51], v[104:105]
    v_cvt_pk_bf16_f32 v110, v48, v49
    v_cvt_pk_bf16_f32 v111, v50, v51
    buffer_store_dwordx2 v[110:111], v9, s[52:55], s69 offen offset:96
    v_lshlrev_b32 v98, 16, v20
    v_and_b32 v99, 4294901760, v20
    v_lshlrev_b32 v100, 16, v21
    v_and_b32 v101, 4294901760, v21
    v_pk_fma_f32 v[52:53], v[80:81], v[92:93], v[52:53] op_sel_hi:[1,0,1] neg_lo:[0,1,0] neg_hi:[0,1,0]
    v_pk_fma_f32 v[54:55], v[82:83], v[92:93], v[54:55] op_sel_hi:[1,0,1] neg_lo:[0,1,0] neg_hi:[0,1,0]
    v_pk_mul_f32 v[52:53], v[52:53], v[92:93] op_sel:[0,1] op_sel_hi:[1,1]
    v_pk_mul_f32 v[54:55], v[54:55], v[92:93] op_sel:[0,1] op_sel_hi:[1,1]
    v_cvt_pk_bf16_f32 v106, v52, v53
    v_cvt_pk_bf16_f32 v107, v54, v55
    v_lshlrev_b32 v52, 16, v106
    v_and_b32 v53, 4294901760, v106
    v_lshlrev_b32 v54, 16, v107
    v_and_b32 v55, 4294901760, v107
    v_pk_add_f32 v[52:53], v[52:53], v[98:99]
    v_pk_add_f32 v[54:55], v[54:55], v[100:101]
    v_cvt_pk_bf16_f32 v106, v52, v53
    v_cvt_pk_bf16_f32 v107, v54, v55
    v_lshlrev_b32 v52, 16, v106
    v_and_b32 v53, 4294901760, v106
    v_lshlrev_b32 v54, 16, v107
    v_and_b32 v55, 4294901760, v107
    v_pk_mul_f32 v[102:103], v[52:53], v[52:53]
    v_pk_mul_f32 v[104:105], v[54:55], v[54:55]
    v_pk_fma_f32 v[102:103], v[102:103], s[70:71], v[94:95]
    v_pk_fma_f32 v[104:105], v[104:105], s[70:71], v[94:95]
    v_pk_mul_f32 v[102:103], v[102:103], v[52:53]
    v_pk_mul_f32 v[104:105], v[104:105], v[54:55]
    v_exp_f32 v102, v102
    v_exp_f32 v103, v103
    v_exp_f32 v104, v104
    v_exp_f32 v105, v105
    v_pk_add_f32 v[102:103], v[102:103], v[96:97]
    v_pk_add_f32 v[104:105], v[104:105], v[96:97]
    v_rcp_f32 v102, v102
    v_rcp_f32 v103, v103
    v_rcp_f32 v104, v104
    v_rcp_f32 v105, v105
    v_pk_mul_f32 v[52:53], v[52:53], v[102:103]
    v_pk_mul_f32 v[54:55], v[54:55], v[104:105]
    v_cvt_pk_bf16_f32 v108, v52, v53
    v_cvt_pk_bf16_f32 v109, v54, v55
    buffer_store_dwordx2 v[108:109], v9, s[52:55], s69 offen offset:128
    v_lshlrev_b32 v98, 16, v22
    v_and_b32 v99, 4294901760, v22
    v_lshlrev_b32 v100, 16, v23
    v_and_b32 v101, 4294901760, v23
    v_pk_fma_f32 v[56:57], v[84:85], v[92:93], v[56:57] op_sel_hi:[1,0,1] neg_lo:[0,1,0] neg_hi:[0,1,0]
    v_pk_fma_f32 v[58:59], v[86:87], v[92:93], v[58:59] op_sel_hi:[1,0,1] neg_lo:[0,1,0] neg_hi:[0,1,0]
    v_pk_mul_f32 v[56:57], v[56:57], v[92:93] op_sel:[0,1] op_sel_hi:[1,1]
    v_pk_mul_f32 v[58:59], v[58:59], v[92:93] op_sel:[0,1] op_sel_hi:[1,1]
    v_cvt_pk_bf16_f32 v106, v56, v57
    v_cvt_pk_bf16_f32 v107, v58, v59
    v_lshlrev_b32 v56, 16, v106
    v_and_b32 v57, 4294901760, v106
    v_lshlrev_b32 v58, 16, v107
    v_and_b32 v59, 4294901760, v107
    v_pk_add_f32 v[56:57], v[56:57], v[98:99]
    v_pk_add_f32 v[58:59], v[58:59], v[100:101]
    v_cvt_pk_bf16_f32 v106, v56, v57
    v_cvt_pk_bf16_f32 v107, v58, v59
    v_lshlrev_b32 v56, 16, v106
    v_and_b32 v57, 4294901760, v106
    v_lshlrev_b32 v58, 16, v107
    v_and_b32 v59, 4294901760, v107
    v_pk_mul_f32 v[102:103], v[56:57], v[56:57]
    v_pk_mul_f32 v[104:105], v[58:59], v[58:59]
    v_pk_fma_f32 v[102:103], v[102:103], s[70:71], v[94:95]
    v_pk_fma_f32 v[104:105], v[104:105], s[70:71], v[94:95]
    v_pk_mul_f32 v[102:103], v[102:103], v[56:57]
    v_pk_mul_f32 v[104:105], v[104:105], v[58:59]
    v_exp_f32 v102, v102
    v_exp_f32 v103, v103
    v_exp_f32 v104, v104
    v_exp_f32 v105, v105
    v_pk_add_f32 v[102:103], v[102:103], v[96:97]
    v_pk_add_f32 v[104:105], v[104:105], v[96:97]
    v_rcp_f32 v102, v102
    v_rcp_f32 v103, v103
    v_rcp_f32 v104, v104
    v_rcp_f32 v105, v105
    v_pk_mul_f32 v[56:57], v[56:57], v[102:103]
    v_pk_mul_f32 v[58:59], v[58:59], v[104:105]
    v_cvt_pk_bf16_f32 v110, v56, v57
    v_cvt_pk_bf16_f32 v111, v58, v59
    buffer_store_dwordx2 v[110:111], v9, s[52:55], s69 offen offset:160
    v_lshlrev_b32 v98, 16, v24
    v_and_b32 v99, 4294901760, v24
    v_lshlrev_b32 v100, 16, v25
    v_and_b32 v101, 4294901760, v25
    v_pk_fma_f32 v[60:61], v[88:89], v[92:93], v[60:61] op_sel_hi:[1,0,1] neg_lo:[0,1,0] neg_hi:[0,1,0]
    v_pk_fma_f32 v[62:63], v[90:91], v[92:93], v[62:63] op_sel_hi:[1,0,1] neg_lo:[0,1,0] neg_hi:[0,1,0]
    v_pk_mul_f32 v[60:61], v[60:61], v[92:93] op_sel:[0,1] op_sel_hi:[1,1]
    v_pk_mul_f32 v[62:63], v[62:63], v[92:93] op_sel:[0,1] op_sel_hi:[1,1]
    v_cvt_pk_bf16_f32 v106, v60, v61
    v_cvt_pk_bf16_f32 v107, v62, v63
    v_lshlrev_b32 v60, 16, v106
    v_and_b32 v61, 4294901760, v106
    v_lshlrev_b32 v62, 16, v107
    v_and_b32 v63, 4294901760, v107
    v_pk_add_f32 v[60:61], v[60:61], v[98:99]
    v_pk_add_f32 v[62:63], v[62:63], v[100:101]
    v_cvt_pk_bf16_f32 v106, v60, v61
    v_cvt_pk_bf16_f32 v107, v62, v63
    v_lshlrev_b32 v60, 16, v106
    v_and_b32 v61, 4294901760, v106
    v_lshlrev_b32 v62, 16, v107
    v_and_b32 v63, 4294901760, v107
    v_pk_mul_f32 v[102:103], v[60:61], v[60:61]
    v_pk_mul_f32 v[104:105], v[62:63], v[62:63]
    v_pk_fma_f32 v[102:103], v[102:103], s[70:71], v[94:95]
    v_pk_fma_f32 v[104:105], v[104:105], s[70:71], v[94:95]
    v_pk_mul_f32 v[102:103], v[102:103], v[60:61]
    v_pk_mul_f32 v[104:105], v[104:105], v[62:63]
    v_exp_f32 v102, v102
    v_exp_f32 v103, v103
    v_exp_f32 v104, v104
    v_exp_f32 v105, v105
    v_pk_add_f32 v[102:103], v[102:103], v[96:97]
    v_pk_add_f32 v[104:105], v[104:105], v[96:97]
    v_rcp_f32 v102, v102
    v_rcp_f32 v103, v103
    v_rcp_f32 v104, v104
    v_rcp_f32 v105, v105
    v_pk_mul_f32 v[60:61], v[60:61], v[102:103]
    v_pk_mul_f32 v[62:63], v[62:63], v[104:105]
    v_cvt_pk_bf16_f32 v108, v60, v61
    v_cvt_pk_bf16_f32 v109, v62, v63
    buffer_store_dwordx2 v[108:109], v9, s[52:55], s69 offen offset:192
    s_nop 3
L_sequential_preLN__sliding_local_dilated__mixer_channel_mlp__prompt_k3_kernel_end:
    s_endpgm
.section .rodata,"a"
.p2align 6
.amdhsa_kernel sequential_preLN__sliding_local_dilated__mixer_channel_mlp__prompt_k3_kernel
  .amdhsa_next_free_vgpr 228
  .amdhsa_next_free_sgpr 72
  .amdhsa_accum_offset 228
  .amdhsa_group_segment_fixed_size 0
  .amdhsa_kernarg_size 88
  .amdhsa_user_sgpr_count 2
  .amdhsa_user_sgpr_kernarg_segment_ptr 1
  .amdhsa_system_sgpr_workgroup_id_x 1
.end_amdhsa_kernel
.text
.globl sequential_preLN__sliding_local_dilated__mixer_channel_mlp__prompt_k4_kernel
.p2align 8
.type sequential_preLN__sliding_local_dilated__mixer_channel_mlp__prompt_k4_kernel,@function
sequential_preLN__sliding_local_dilated__mixer_channel_mlp__prompt_k4_kernel:
    s_cmp_ge_u32 s2, 256
    s_nop 0
    s_cbranch_scc1 L_sequential_preLN__sliding_local_dilated__mixer_channel_mlp__prompt_k4_kernel_end
    s_load_dwordx16 s[16:31], s[0:1], 0
    s_load_dwordx2 s[32:33], s[0:1], 64
    s_load_dwordx2 s[34:35], s[0:1], 80
    v_lshrrev_b32 v2, 6, v0
    v_and_b32 v1, 63, v0
    v_readfirstlane_b32 s3, v2
    s_and_b32 s58, s2, 7
    s_lshl_b32 s56, s58, 2
    s_lshr_b32 s59, s2, 3
    s_and_b32 s60, s59, 3
    s_add_u32 s56, s56, s60
    s_lshr_b32 s57, s59, 2
    s_cmp_ge_u32 s3, 4
    s_nop 0
    s_cbranch_scc1 L_sequential_preLN__sliding_local_dilated__mixer_channel_mlp__prompt_k4_kernel_loader
    v_and_b32 v3, 15, v1
    v_lshrrev_b32 v4, 4, v1
    v_and_b32 v7, 7, v1
    s_and_b32 s59, s3, 1
    s_lshr_b32 s60, s3, 1
    s_lshl_b32 s58, s56, 6
    s_lshl_b32 s61, s59, 5
    s_add_u32 s58, s58, s61
    v_add_u32 v8, s58, v3
    v_lshlrev_b32 v8, 10, v8
    s_lshl_b32 s58, s57, 7
    s_lshl_b32 s61, s60, 6
    s_add_u32 s58, s58, s61
    v_lshl_add_u32 v9, v4, 3, s58
    v_add_u32 v8, v8, v9
    v_add_u32 v5, 0, v4
    v_xor_b32 v5, v5, v7
    v_lshlrev_b32 v5, 4, v5
    v_lshl_add_u32 v5, v3, 7, v5
    s_lshl_b32 s58, s59, 12
    v_add_u32 v10, s58, v5
    v_add_u32 v12, 65536, v10
    v_add_u32 v5, 4, v4
    v_xor_b32 v5, v5, v7
    v_lshlrev_b32 v5, 4, v5
    v_lshl_add_u32 v5, v3, 7, v5
    s_lshl_b32 s58, s59, 12
    v_add_u32 v11, s58, v5
    v_add_u32 v13, 65536, v11
    v_lshrrev_b32 v18, 2, v3
    v_and_b32 v19, 3, v3
    v_lshrrev_b32 v5, 1, v19
    s_lshl_b32 s58, s60, 2
    s_add_u32 s58, s58, 0
    v_add_u32 v5, s58, v5
    v_and_b32 v6, 2, v18
    v_xor_b32 v5, v5, v6
    v_and_b32 v6, 1, v4
    v_lshlrev_b32 v6, 2, v6
    v_xor_b32 v5, v5, v6
    v_lshlrev_b32 v5, 4, v5
    v_and_b32 v6, 1, v19
    v_lshl_add_u32 v5, v6, 3, v5
    v_lshl_add_u32 v6, v4, 3, v18
    v_lshl_add_u32 v5, v6, 7, v5
    v_add_u32 v14, 8192, v5
    v_add_u32 v16, 65536, v14
    v_lshrrev_b32 v5, 1, v19
    s_lshl_b32 s58, s60, 2
    s_add_u32 s58, s58, 2
    v_add_u32 v5, s58, v5
    v_and_b32 v6, 2, v18
    v_xor_b32 v5, v5, v6
    v_and_b32 v6, 1, v4
    v_lshlrev_b32 v6, 2, v6
    v_xor_b32 v5, v5, v6
    v_lshlrev_b32 v5, 4, v5
    v_and_b32 v6, 1, v19
    v_lshl_add_u32 v5, v6, 3, v5
    v_lshl_add_u32 v6, v4, 3, v18
    v_lshl_add_u32 v5, v6, 7, v5
    v_add_u32 v15, 8192, v5
    v_add_u32 v17, 65536, v15
    s_waitcnt lgkmcnt(0)
    s_add_u32 s36, s34, 4194304
    s_addc_u32 s37, s35, 0
    s_and_b32 s37, s37, 65535
    s_mov_b32 s38, 7340032
    s_mov_b32 s39, 131072
    s_mov_b32 s40, s28
    s_and_b32 s41, s29, 65535
    s_mov_b32 s42, 1835008
    s_mov_b32 s43, 131072
    s_add_u32 s44, s34, 2097152
    s_addc_u32 s45, s35, 0
    s_and_b32 s45, s45, 65535
    s_mov_b32 s46, 2097152
    s_mov_b32 s47, 131072
    s_mov_b32 s48, s30
    s_and_b32 s49, s31, 65535
    s_mov_b32 s50, 1024
    s_mov_b32 s51, 131072
    s_mov_b32 s52, s32
    s_and_b32 s53, s33, 65535
    s_mov_b32 s54, 2097152
    s_mov_b32 s55, 131072
    s_mov_b32 s62, 16384
    buffer_load_dwordx2 v[20:21], v8, s[44:47], 0 offen
    buffer_load_dwordx2 v[22:23], v8, s[44:47], s62 offen
    buffer_load_dwordx2 v[24:25], v8, s[44:47], 0 offen offset:32
    buffer_load_dwordx2 v[26:27], v8, s[44:47], s62 offen offset:32
    buffer_load_dwordx2 v[28:29], v9, s[48:51], 0 offen
    buffer_load_dwordx2 v[30:31], v9, s[48:51], 0 offen offset:32
    s_barrier
    ds_read_b64_tr_b16 v[40:41], v14
    ds_read_b64_tr_b16 v[42:43], v14 offset:512
    ds_read_b64_tr_b16 v[44:45], v15
    ds_read_b64_tr_b16 v[46:47], v15 offset:512
    ds_read_b128 v[32:35], v10
    ds_read_b128 v[36:39], v10 offset:2048
    s_waitcnt lgkmcnt(0)
    v_mfma_f32_16x16x32_bf16 v[64:67], v[40:43], v[32:35], 0
    ds_read_b64_tr_b16 v[56:57], v14 offset:4096
    ds_read_b64_tr_b16 v[58:59], v14 offset:4608
    v_mfma_f32_16x16x32_bf16 v[68:71], v[40:43], v[36:39], 0
    ds_read_b64_tr_b16 v[60:61], v15 offset:4096
    ds_read_b64_tr_b16 v[62:63], v15 offset:4608
    v_mfma_f32_16x16x32_bf16 v[72:75], v[44:47], v[32:35], 0
    ds_read_b128 v[48:51], v11
    ds_read_b128 v[52:55], v11 offset:2048
    v_mfma_f32_16x16x32_bf16 v[76:79], v[44:47], v[36:39], 0
    s_waitcnt lgkmcnt(0)
    s_barrier
    v_mfma_f32_16x16x32_bf16 v[64:67], v[56:59], v[48:51], v[64:67]
    ds_read_b64_tr_b16 v[40:41], v14 offset:16384
    ds_read_b64_tr_b16 v[42:43], v14 offset:16896
    v_mfma_f32_16x16x32_bf16 v[68:71], v[56:59], v[52:55], v[68:71]
    ds_read_b64_tr_b16 v[44:45], v15 offset:16384
    ds_read_b64_tr_b16 v[46:47], v15 offset:16896
    v_mfma_f32_16x16x32_bf16 v[72:75], v[60:63], v[48:51], v[72:75]
    ds_read_b128 v[32:35], v10 offset:16384
    ds_read_b128 v[36:39], v10 offset:18432
    v_mfma_f32_16x16x32_bf16 v[76:79], v[60:63], v[52:55], v[76:79]
    s_waitcnt lgkmcnt(0)
    v_mfma_f32_16x16x32_bf16 v[64:67], v[40:43], v[32:35], v[64:67]
    ds_read_b64_tr_b16 v[56:57], v14 offset:20480
    ds_read_b64_tr_b16 v[58:59], v14 offset:20992
    v_mfma_f32_16x16x32_bf16 v[68:71], v[40:43], v[36:39], v[68:71]
    ds_read_b64_tr_b16 v[60:61], v15 offset:20480
    ds_read_b64_tr_b16 v[62:63], v15 offset:20992
    v_mfma_f32_16x16x32_bf16 v[72:75], v[44:47], v[32:35], v[72:75]
    ds_read_b128 v[48:51], v11 offset:16384
    ds_read_b128 v[52:55], v11 offset:18432
    v_mfma_f32_16x16x32_bf16 v[76:79], v[44:47], v[36:39], v[76:79]
    s_waitcnt lgkmcnt(0)
    s_barrier
    v_mfma_f32_16x16x32_bf16 v[64:67], v[56:59], v[48:51], v[64:67]
    ds_read_b64_tr_b16 v[40:41], v14 offset:32768
    ds_read_b64_tr_b16 v[42:43], v14 offset:33280
    v_mfma_f32_16x16x32_bf16 v[68:71], v[56:59], v[52:55], v[68:71]
    ds_read_b64_tr_b16 v[44:45], v15 offset:32768
    ds_read_b64_tr_b16 v[46:47], v15 offset:33280
    v_mfma_f32_16x16x32_bf16 v[72:75], v[60:63], v[48:51], v[72:75]
    ds_read_b128 v[32:35], v10 offset:32768
    ds_read_b128 v[36:39], v10 offset:34816
    v_mfma_f32_16x16x32_bf16 v[76:79], v[60:63], v[52:55], v[76:79]
    s_waitcnt lgkmcnt(0)
    v_mfma_f32_16x16x32_bf16 v[64:67], v[40:43], v[32:35], v[64:67]
    ds_read_b64_tr_b16 v[56:57], v14 offset:36864
    ds_read_b64_tr_b16 v[58:59], v14 offset:37376
    v_mfma_f32_16x16x32_bf16 v[68:71], v[40:43], v[36:39], v[68:71]
    ds_read_b64_tr_b16 v[60:61], v15 offset:36864
    ds_read_b64_tr_b16 v[62:63], v15 offset:37376
    v_mfma_f32_16x16x32_bf16 v[72:75], v[44:47], v[32:35], v[72:75]
    ds_read_b128 v[48:51], v11 offset:32768
    ds_read_b128 v[52:55], v11 offset:34816
    v_mfma_f32_16x16x32_bf16 v[76:79], v[44:47], v[36:39], v[76:79]
    s_waitcnt lgkmcnt(0)
    s_barrier
    v_mfma_f32_16x16x32_bf16 v[64:67], v[56:59], v[48:51], v[64:67]
    ds_read_b64_tr_b16 v[40:41], v14 offset:49152
    ds_read_b64_tr_b16 v[42:43], v14 offset:49664
    v_mfma_f32_16x16x32_bf16 v[68:71], v[56:59], v[52:55], v[68:71]
    ds_read_b64_tr_b16 v[44:45], v15 offset:49152
    ds_read_b64_tr_b16 v[46:47], v15 offset:49664
    v_mfma_f32_16x16x32_bf16 v[72:75], v[60:63], v[48:51], v[72:75]
    ds_read_b128 v[32:35], v10 offset:49152
    ds_read_b128 v[36:39], v10 offset:51200
    v_mfma_f32_16x16x32_bf16 v[76:79], v[60:63], v[52:55], v[76:79]
    s_waitcnt lgkmcnt(0)
    v_mfma_f32_16x16x32_bf16 v[64:67], v[40:43], v[32:35], v[64:67]
    ds_read_b64_tr_b16 v[56:57], v14 offset:53248
    ds_read_b64_tr_b16 v[58:59], v14 offset:53760
    v_mfma_f32_16x16x32_bf16 v[68:71], v[40:43], v[36:39], v[68:71]
    ds_read_b64_tr_b16 v[60:61], v15 offset:53248
    ds_read_b64_tr_b16 v[62:63], v15 offset:53760
    v_mfma_f32_16x16x32_bf16 v[72:75], v[44:47], v[32:35], v[72:75]
    ds_read_b128 v[48:51], v11 offset:49152
    ds_read_b128 v[52:55], v11 offset:51200
    v_mfma_f32_16x16x32_bf16 v[76:79], v[44:47], v[36:39], v[76:79]
    s_waitcnt lgkmcnt(0)
    s_barrier
    v_mfma_f32_16x16x32_bf16 v[64:67], v[56:59], v[48:51], v[64:67]
    ds_read_b64_tr_b16 v[40:41], v16
    ds_read_b64_tr_b16 v[42:43], v16 offset:512
    v_mfma_f32_16x16x32_bf16 v[68:71], v[56:59], v[52:55], v[68:71]
    ds_read_b64_tr_b16 v[44:45], v17
    ds_read_b64_tr_b16 v[46:47], v17 offset:512
    v_mfma_f32_16x16x32_bf16 v[72:75], v[60:63], v[48:51], v[72:75]
    ds_read_b128 v[32:35], v12
    ds_read_b128 v[36:39], v12 offset:2048
    v_mfma_f32_16x16x32_bf16 v[76:79], v[60:63], v[52:55], v[76:79]
    s_waitcnt lgkmcnt(0)
    v_mfma_f32_16x16x32_bf16 v[64:67], v[40:43], v[32:35], v[64:67]
    ds_read_b64_tr_b16 v[56:57], v16 offset:4096
    ds_read_b64_tr_b16 v[58:59], v16 offset:4608
    v_mfma_f32_16x16x32_bf16 v[68:71], v[40:43], v[36:39], v[68:71]
    ds_read_b64_tr_b16 v[60:61], v17 offset:4096
    ds_read_b64_tr_b16 v[62:63], v17 offset:4608
    v_mfma_f32_16x16x32_bf16 v[72:75], v[44:47], v[32:35], v[72:75]
    ds_read_b128 v[48:51], v13
    ds_read_b128 v[52:55], v13 offset:2048
    v_mfma_f32_16x16x32_bf16 v[76:79], v[44:47], v[36:39], v[76:79]
    s_waitcnt lgkmcnt(0)
    s_barrier
    v_mfma_f32_16x16x32_bf16 v[64:67], v[56:59], v[48:51], v[64:67]
    ds_read_b64_tr_b16 v[40:41], v16 offset:16384
    ds_read_b64_tr_b16 v[42:43], v16 offset:16896
    v_mfma_f32_16x16x32_bf16 v[68:71], v[56:59], v[52:55], v[68:71]
    ds_read_b64_tr_b16 v[44:45], v17 offset:16384
    ds_read_b64_tr_b16 v[46:47], v17 offset:16896
    v_mfma_f32_16x16x32_bf16 v[72:75], v[60:63], v[48:51], v[72:75]
    ds_read_b128 v[32:35], v12 offset:16384
    ds_read_b128 v[36:39], v12 offset:18432
    v_mfma_f32_16x16x32_bf16 v[76:79], v[60:63], v[52:55], v[76:79]
    s_waitcnt lgkmcnt(0)
    v_mfma_f32_16x16x32_bf16 v[64:67], v[40:43], v[32:35], v[64:67]
    ds_read_b64_tr_b16 v[56:57], v16 offset:20480
    ds_read_b64_tr_b16 v[58:59], v16 offset:20992
    v_mfma_f32_16x16x32_bf16 v[68:71], v[40:43], v[36:39], v[68:71]
    ds_read_b64_tr_b16 v[60:61], v17 offset:20480
    ds_read_b64_tr_b16 v[62:63], v17 offset:20992
    v_mfma_f32_16x16x32_bf16 v[72:75], v[44:47], v[32:35], v[72:75]
    ds_read_b128 v[48:51], v13 offset:16384
    ds_read_b128 v[52:55], v13 offset:18432
    v_mfma_f32_16x16x32_bf16 v[76:79], v[44:47], v[36:39], v[76:79]
    s_waitcnt lgkmcnt(0)
    s_barrier
    v_mfma_f32_16x16x32_bf16 v[64:67], v[56:59], v[48:51], v[64:67]
    ds_read_b64_tr_b16 v[40:41], v16 offset:32768
    ds_read_b64_tr_b16 v[42:43], v16 offset:33280
    v_mfma_f32_16x16x32_bf16 v[68:71], v[56:59], v[52:55], v[68:71]
    ds_read_b64_tr_b16 v[44:45], v17 offset:32768
    ds_read_b64_tr_b16 v[46:47], v17 offset:33280
    v_mfma_f32_16x16x32_bf16 v[72:75], v[60:63], v[48:51], v[72:75]
    ds_read_b128 v[32:35], v12 offset:32768
    ds_read_b128 v[36:39], v12 offset:34816
    v_mfma_f32_16x16x32_bf16 v[76:79], v[60:63], v[52:55], v[76:79]
    s_waitcnt lgkmcnt(0)
    v_mfma_f32_16x16x32_bf16 v[64:67], v[40:43], v[32:35], v[64:67]
    ds_read_b64_tr_b16 v[56:57], v16 offset:36864
    ds_read_b64_tr_b16 v[58:59], v16 offset:37376
    v_mfma_f32_16x16x32_bf16 v[68:71], v[40:43], v[36:39], v[68:71]
    ds_read_b64_tr_b16 v[60:61], v17 offset:36864
    ds_read_b64_tr_b16 v[62:63], v17 offset:37376
    v_mfma_f32_16x16x32_bf16 v[72:75], v[44:47], v[32:35], v[72:75]
    ds_read_b128 v[48:51], v13 offset:32768
    ds_read_b128 v[52:55], v13 offset:34816
    v_mfma_f32_16x16x32_bf16 v[76:79], v[44:47], v[36:39], v[76:79]
    s_waitcnt lgkmcnt(0)
    s_barrier
    v_mfma_f32_16x16x32_bf16 v[64:67], v[56:59], v[48:51], v[64:67]
    ds_read_b64_tr_b16 v[40:41], v16 offset:49152
    ds_read_b64_tr_b16 v[42:43], v16 offset:49664
    v_mfma_f32_16x16x32_bf16 v[68:71], v[56:59], v[52:55], v[68:71]
    ds_read_b64_tr_b16 v[44:45], v17 offset:49152
    ds_read_b64_tr_b16 v[46:47], v17 offset:49664
    v_mfma_f32_16x16x32_bf16 v[72:75], v[60:63], v[48:51], v[72:75]
    ds_read_b128 v[32:35], v12 offset:49152
    ds_read_b128 v[36:39], v12 offset:51200
    v_mfma_f32_16x16x32_bf16 v[76:79], v[60:63], v[52:55], v[76:79]
    s_waitcnt lgkmcnt(0)
    v_mfma_f32_16x16x32_bf16 v[64:67], v[40:43], v[32:35], v[64:67]
    ds_read_b64_tr_b16 v[56:57], v16 offset:53248
    ds_read_b64_tr_b16 v[58:59], v16 offset:53760
    v_mfma_f32_16x16x32_bf16 v[68:71], v[40:43], v[36:39], v[68:71]
    ds_read_b64_tr_b16 v[60:61], v17 offset:53248
    ds_read_b64_tr_b16 v[62:63], v17 offset:53760
    v_mfma_f32_16x16x32_bf16 v[72:75], v[44:47], v[32:35], v[72:75]
    ds_read_b128 v[48:51], v13 offset:49152
    ds_read_b128 v[52:55], v13 offset:51200
    v_mfma_f32_16x16x32_bf16 v[76:79], v[44:47], v[36:39], v[76:79]
    s_waitcnt lgkmcnt(0)
    s_barrier
    v_mfma_f32_16x16x32_bf16 v[64:67], v[56:59], v[48:51], v[64:67]
    ds_read_b64_tr_b16 v[40:41], v14
    ds_read_b64_tr_b16 v[42:43], v14 offset:512
    v_mfma_f32_16x16x32_bf16 v[68:71], v[56:59], v[52:55], v[68:71]
    ds_read_b64_tr_b16 v[44:45], v15
    ds_read_b64_tr_b16 v[46:47], v15 offset:512
    v_mfma_f32_16x16x32_bf16 v[72:75], v[60:63], v[48:51], v[72:75]
    ds_read_b128 v[32:35], v10
    ds_read_b128 v[36:39], v10 offset:2048
    v_mfma_f32_16x16x32_bf16 v[76:79], v[60:63], v[52:55], v[76:79]
    s_waitcnt lgkmcnt(0)
    v_mfma_f32_16x16x32_bf16 v[64:67], v[40:43], v[32:35], v[64:67]
    ds_read_b64_tr_b16 v[56:57], v14 offset:4096
    ds_read_b64_tr_b16 v[58:59], v14 offset:4608
    v_mfma_f32_16x16x32_bf16 v[68:71], v[40:43], v[36:39], v[68:71]
    ds_read_b64_tr_b16 v[60:61], v15 offset:4096
    ds_read_b64_tr_b16 v[62:63], v15 offset:4608
    v_mfma_f32_16x16x32_bf16 v[72:75], v[44:47], v[32:35], v[72:75]
    ds_read_b128 v[48:51], v11
    ds_read_b128 v[52:55], v11 offset:2048
    v_mfma_f32_16x16x32_bf16 v[76:79], v[44:47], v[36:39], v[76:79]
    s_waitcnt lgkmcnt(0)
    s_barrier
    v_mfma_f32_16x16x32_bf16 v[64:67], v[56:59], v[48:51], v[64:67]
    ds_read_b64_tr_b16 v[40:41], v14 offset:16384
    ds_read_b64_tr_b16 v[42:43], v14 offset:16896
    v_mfma_f32_16x16x32_bf16 v[68:71], v[56:59], v[52:55], v[68:71]
    ds_read_b64_tr_b16 v[44:45], v15 offset:16384
    ds_read_b64_tr_b16 v[46:47], v15 offset:16896
    v_mfma_f32_16x16x32_bf16 v[72:75], v[60:63], v[48:51], v[72:75]
    ds_read_b128 v[32:35], v10 offset:16384
    ds_read_b128 v[36:39], v10 offset:18432
    v_mfma_f32_16x16x32_bf16 v[76:79], v[60:63], v[52:55], v[76:79]
    s_waitcnt lgkmcnt(0)
    v_mfma_f32_16x16x32_bf16 v[64:67], v[40:43], v[32:35], v[64:67]
    ds_read_b64_tr_b16 v[56:57], v14 offset:20480
    ds_read_b64_tr_b16 v[58:59], v14 offset:20992
    v_mfma_f32_16x16x32_bf16 v[68:71], v[40:43], v[36:39], v[68:71]
    ds_read_b64_tr_b16 v[60:61], v15 offset:20480
    ds_read_b64_tr_b16 v[62:63], v15 offset:20992
    v_mfma_f32_16x16x32_bf16 v[72:75], v[44:47], v[32:35], v[72:75]
    ds_read_b128 v[48:51], v11 offset:16384
    ds_read_b128 v[52:55], v11 offset:18432
    v_mfma_f32_16x16x32_bf16 v[76:79], v[44:47], v[36:39], v[76:79]
    s_waitcnt lgkmcnt(0)
    s_barrier
    v_mfma_f32_16x16x32_bf16 v[64:67], v[56:59], v[48:51], v[64:67]
    ds_read_b64_tr_b16 v[40:41], v14 offset:32768
    ds_read_b64_tr_b16 v[42:43], v14 offset:33280
    v_mfma_f32_16x16x32_bf16 v[68:71], v[56:59], v[52:55], v[68:71]
    ds_read_b64_tr_b16 v[44:45], v15 offset:32768
    ds_read_b64_tr_b16 v[46:47], v15 offset:33280
    v_mfma_f32_16x16x32_bf16 v[72:75], v[60:63], v[48:51], v[72:75]
    ds_read_b128 v[32:35], v10 offset:32768
    ds_read_b128 v[36:39], v10 offset:34816
    v_mfma_f32_16x16x32_bf16 v[76:79], v[60:63], v[52:55], v[76:79]
    s_waitcnt lgkmcnt(0)
    v_mfma_f32_16x16x32_bf16 v[64:67], v[40:43], v[32:35], v[64:67]
    ds_read_b64_tr_b16 v[56:57], v14 offset:36864
    ds_read_b64_tr_b16 v[58:59], v14 offset:37376
    v_mfma_f32_16x16x32_bf16 v[68:71], v[40:43], v[36:39], v[68:71]
    ds_read_b64_tr_b16 v[60:61], v15 offset:36864
    ds_read_b64_tr_b16 v[62:63], v15 offset:37376
    v_mfma_f32_16x16x32_bf16 v[72:75], v[44:47], v[32:35], v[72:75]
    ds_read_b128 v[48:51], v11 offset:32768
    ds_read_b128 v[52:55], v11 offset:34816
    v_mfma_f32_16x16x32_bf16 v[76:79], v[44:47], v[36:39], v[76:79]
    s_waitcnt lgkmcnt(0)
    s_barrier
    v_mfma_f32_16x16x32_bf16 v[64:67], v[56:59], v[48:51], v[64:67]
    ds_read_b64_tr_b16 v[40:41], v14 offset:49152
    ds_read_b64_tr_b16 v[42:43], v14 offset:49664
    v_mfma_f32_16x16x32_bf16 v[68:71], v[56:59], v[52:55], v[68:71]
    ds_read_b64_tr_b16 v[44:45], v15 offset:49152
    ds_read_b64_tr_b16 v[46:47], v15 offset:49664
    v_mfma_f32_16x16x32_bf16 v[72:75], v[60:63], v[48:51], v[72:75]
    ds_read_b128 v[32:35], v10 offset:49152
    ds_read_b128 v[36:39], v10 offset:51200
    v_mfma_f32_16x16x32_bf16 v[76:79], v[60:63], v[52:55], v[76:79]
    s_waitcnt lgkmcnt(0)
    v_mfma_f32_16x16x32_bf16 v[64:67], v[40:43], v[32:35], v[64:67]
    ds_read_b64_tr_b16 v[56:57], v14 offset:53248
    ds_read_b64_tr_b16 v[58:59], v14 offset:53760
    v_mfma_f32_16x16x32_bf16 v[68:71], v[40:43], v[36:39], v[68:71]
    ds_read_b64_tr_b16 v[60:61], v15 offset:53248
    ds_read_b64_tr_b16 v[62:63], v15 offset:53760
    v_mfma_f32_16x16x32_bf16 v[72:75], v[44:47], v[32:35], v[72:75]
    ds_read_b128 v[48:51], v11 offset:49152
    ds_read_b128 v[52:55], v11 offset:51200
    v_mfma_f32_16x16x32_bf16 v[76:79], v[44:47], v[36:39], v[76:79]
    s_waitcnt lgkmcnt(0)
    s_barrier
    v_mfma_f32_16x16x32_bf16 v[64:67], v[56:59], v[48:51], v[64:67]
    ds_read_b64_tr_b16 v[40:41], v16
    ds_read_b64_tr_b16 v[42:43], v16 offset:512
    v_mfma_f32_16x16x32_bf16 v[68:71], v[56:59], v[52:55], v[68:71]
    ds_read_b64_tr_b16 v[44:45], v17
    ds_read_b64_tr_b16 v[46:47], v17 offset:512
    v_mfma_f32_16x16x32_bf16 v[72:75], v[60:63], v[48:51], v[72:75]
    ds_read_b128 v[32:35], v12
    ds_read_b128 v[36:39], v12 offset:2048
    v_mfma_f32_16x16x32_bf16 v[76:79], v[60:63], v[52:55], v[76:79]
    s_waitcnt lgkmcnt(0)
    v_mfma_f32_16x16x32_bf16 v[64:67], v[40:43], v[32:35], v[64:67]
    ds_read_b64_tr_b16 v[56:57], v16 offset:4096
    ds_read_b64_tr_b16 v[58:59], v16 offset:4608
    v_mfma_f32_16x16x32_bf16 v[68:71], v[40:43], v[36:39], v[68:71]
    ds_read_b64_tr_b16 v[60:61], v17 offset:4096
    ds_read_b64_tr_b16 v[62:63], v17 offset:4608
    v_mfma_f32_16x16x32_bf16 v[72:75], v[44:47], v[32:35], v[72:75]
    ds_read_b128 v[48:51], v13
    ds_read_b128 v[52:55], v13 offset:2048
    v_mfma_f32_16x16x32_bf16 v[76:79], v[44:47], v[36:39], v[76:79]
    s_waitcnt lgkmcnt(0)
    s_barrier
    v_mfma_f32_16x16x32_bf16 v[64:67], v[56:59], v[48:51], v[64:67]
    ds_read_b64_tr_b16 v[40:41], v16 offset:16384
    ds_read_b64_tr_b16 v[42:43], v16 offset:16896
    v_mfma_f32_16x16x32_bf16 v[68:71], v[56:59], v[52:55], v[68:71]
    ds_read_b64_tr_b16 v[44:45], v17 offset:16384
    ds_read_b64_tr_b16 v[46:47], v17 offset:16896
    v_mfma_f32_16x16x32_bf16 v[72:75], v[60:63], v[48:51], v[72:75]
    ds_read_b128 v[32:35], v12 offset:16384
    ds_read_b128 v[36:39], v12 offset:18432
    v_mfma_f32_16x16x32_bf16 v[76:79], v[60:63], v[52:55], v[76:79]
    s_waitcnt lgkmcnt(0)
    v_mfma_f32_16x16x32_bf16 v[64:67], v[40:43], v[32:35], v[64:67]
    ds_read_b64_tr_b16 v[56:57], v16 offset:20480
    ds_read_b64_tr_b16 v[58:59], v16 offset:20992
    v_mfma_f32_16x16x32_bf16 v[68:71], v[40:43], v[36:39], v[68:71]
    ds_read_b64_tr_b16 v[60:61], v17 offset:20480
    ds_read_b64_tr_b16 v[62:63], v17 offset:20992
    v_mfma_f32_16x16x32_bf16 v[72:75], v[44:47], v[32:35], v[72:75]
    ds_read_b128 v[48:51], v13 offset:16384
    ds_read_b128 v[52:55], v13 offset:18432
    v_mfma_f32_16x16x32_bf16 v[76:79], v[44:47], v[36:39], v[76:79]
    s_waitcnt lgkmcnt(0)
    s_barrier
    v_mfma_f32_16x16x32_bf16 v[64:67], v[56:59], v[48:51], v[64:67]
    ds_read_b64_tr_b16 v[40:41], v16 offset:32768
    ds_read_b64_tr_b16 v[42:43], v16 offset:33280
    v_mfma_f32_16x16x32_bf16 v[68:71], v[56:59], v[52:55], v[68:71]
    ds_read_b64_tr_b16 v[44:45], v17 offset:32768
    ds_read_b64_tr_b16 v[46:47], v17 offset:33280
    v_mfma_f32_16x16x32_bf16 v[72:75], v[60:63], v[48:51], v[72:75]
    ds_read_b128 v[32:35], v12 offset:32768
    ds_read_b128 v[36:39], v12 offset:34816
    v_mfma_f32_16x16x32_bf16 v[76:79], v[60:63], v[52:55], v[76:79]
    s_waitcnt lgkmcnt(0)
    v_mfma_f32_16x16x32_bf16 v[64:67], v[40:43], v[32:35], v[64:67]
    ds_read_b64_tr_b16 v[56:57], v16 offset:36864
    ds_read_b64_tr_b16 v[58:59], v16 offset:37376
    v_mfma_f32_16x16x32_bf16 v[68:71], v[40:43], v[36:39], v[68:71]
    ds_read_b64_tr_b16 v[60:61], v17 offset:36864
    ds_read_b64_tr_b16 v[62:63], v17 offset:37376
    v_mfma_f32_16x16x32_bf16 v[72:75], v[44:47], v[32:35], v[72:75]
    ds_read_b128 v[48:51], v13 offset:32768
    ds_read_b128 v[52:55], v13 offset:34816
    v_mfma_f32_16x16x32_bf16 v[76:79], v[44:47], v[36:39], v[76:79]
    s_waitcnt lgkmcnt(0)
    s_barrier
    v_mfma_f32_16x16x32_bf16 v[64:67], v[56:59], v[48:51], v[64:67]
    ds_read_b64_tr_b16 v[40:41], v16 offset:49152
    ds_read_b64_tr_b16 v[42:43], v16 offset:49664
    v_mfma_f32_16x16x32_bf16 v[68:71], v[56:59], v[52:55], v[68:71]
    ds_read_b64_tr_b16 v[44:45], v17 offset:49152
    ds_read_b64_tr_b16 v[46:47], v17 offset:49664
    v_mfma_f32_16x16x32_bf16 v[72:75], v[60:63], v[48:51], v[72:75]
    ds_read_b128 v[32:35], v12 offset:49152
    ds_read_b128 v[36:39], v12 offset:51200
    v_mfma_f32_16x16x32_bf16 v[76:79], v[60:63], v[52:55], v[76:79]
    s_waitcnt lgkmcnt(0)
    v_mfma_f32_16x16x32_bf16 v[64:67], v[40:43], v[32:35], v[64:67]
    ds_read_b64_tr_b16 v[56:57], v16 offset:53248
    ds_read_b64_tr_b16 v[58:59], v16 offset:53760
    v_mfma_f32_16x16x32_bf16 v[68:71], v[40:43], v[36:39], v[68:71]
    ds_read_b64_tr_b16 v[60:61], v17 offset:53248
    ds_read_b64_tr_b16 v[62:63], v17 offset:53760
    v_mfma_f32_16x16x32_bf16 v[72:75], v[44:47], v[32:35], v[72:75]
    ds_read_b128 v[48:51], v13 offset:49152
    ds_read_b128 v[52:55], v13 offset:51200
    v_mfma_f32_16x16x32_bf16 v[76:79], v[44:47], v[36:39], v[76:79]
    s_waitcnt lgkmcnt(0)
    s_barrier
    v_mfma_f32_16x16x32_bf16 v[64:67], v[56:59], v[48:51], v[64:67]
    ds_read_b64_tr_b16 v[40:41], v14
    ds_read_b64_tr_b16 v[42:43], v14 offset:512
    v_mfma_f32_16x16x32_bf16 v[68:71], v[56:59], v[52:55], v[68:71]
    ds_read_b64_tr_b16 v[44:45], v15
    ds_read_b64_tr_b16 v[46:47], v15 offset:512
    v_mfma_f32_16x16x32_bf16 v[72:75], v[60:63], v[48:51], v[72:75]
    ds_read_b128 v[32:35], v10
    ds_read_b128 v[36:39], v10 offset:2048
    v_mfma_f32_16x16x32_bf16 v[76:79], v[60:63], v[52:55], v[76:79]
    s_waitcnt lgkmcnt(0)
    v_mfma_f32_16x16x32_bf16 v[64:67], v[40:43], v[32:35], v[64:67]
    ds_read_b64_tr_b16 v[56:57], v14 offset:4096
    ds_read_b64_tr_b16 v[58:59], v14 offset:4608
    v_mfma_f32_16x16x32_bf16 v[68:71], v[40:43], v[36:39], v[68:71]
    ds_read_b64_tr_b16 v[60:61], v15 offset:4096
    ds_read_b64_tr_b16 v[62:63], v15 offset:4608
    v_mfma_f32_16x16x32_bf16 v[72:75], v[44:47], v[32:35], v[72:75]
    ds_read_b128 v[48:51], v11
    ds_read_b128 v[52:55], v11 offset:2048
    v_mfma_f32_16x16x32_bf16 v[76:79], v[44:47], v[36:39], v[76:79]
    s_waitcnt lgkmcnt(0)
    s_barrier
    v_mfma_f32_16x16x32_bf16 v[64:67], v[56:59], v[48:51], v[64:67]
    ds_read_b64_tr_b16 v[40:41], v14 offset:16384
    ds_read_b64_tr_b16 v[42:43], v14 offset:16896
    v_mfma_f32_16x16x32_bf16 v[68:71], v[56:59], v[52:55], v[68:71]
    ds_read_b64_tr_b16 v[44:45], v15 offset:16384
    ds_read_b64_tr_b16 v[46:47], v15 offset:16896
    v_mfma_f32_16x16x32_bf16 v[72:75], v[60:63], v[48:51], v[72:75]
    ds_read_b128 v[32:35], v10 offset:16384
    ds_read_b128 v[36:39], v10 offset:18432
    v_mfma_f32_16x16x32_bf16 v[76:79], v[60:63], v[52:55], v[76:79]
    s_waitcnt lgkmcnt(0)
    v_mfma_f32_16x16x32_bf16 v[64:67], v[40:43], v[32:35], v[64:67]
    ds_read_b64_tr_b16 v[56:57], v14 offset:20480
    ds_read_b64_tr_b16 v[58:59], v14 offset:20992
    v_mfma_f32_16x16x32_bf16 v[68:71], v[40:43], v[36:39], v[68:71]
    ds_read_b64_tr_b16 v[60:61], v15 offset:20480
    ds_read_b64_tr_b16 v[62:63], v15 offset:20992
    v_mfma_f32_16x16x32_bf16 v[72:75], v[44:47], v[32:35], v[72:75]
    ds_read_b128 v[48:51], v11 offset:16384
    ds_read_b128 v[52:55], v11 offset:18432
    v_mfma_f32_16x16x32_bf16 v[76:79], v[44:47], v[36:39], v[76:79]
    s_waitcnt lgkmcnt(0)
    s_barrier
    v_mfma_f32_16x16x32_bf16 v[64:67], v[56:59], v[48:51], v[64:67]
    ds_read_b64_tr_b16 v[40:41], v14 offset:32768
    ds_read_b64_tr_b16 v[42:43], v14 offset:33280
    v_mfma_f32_16x16x32_bf16 v[68:71], v[56:59], v[52:55], v[68:71]
    ds_read_b64_tr_b16 v[44:45], v15 offset:32768
    ds_read_b64_tr_b16 v[46:47], v15 offset:33280
    v_mfma_f32_16x16x32_bf16 v[72:75], v[60:63], v[48:51], v[72:75]
    ds_read_b128 v[32:35], v10 offset:32768
    ds_read_b128 v[36:39], v10 offset:34816
    v_mfma_f32_16x16x32_bf16 v[76:79], v[60:63], v[52:55], v[76:79]
    s_waitcnt lgkmcnt(0)
    v_mfma_f32_16x16x32_bf16 v[64:67], v[40:43], v[32:35], v[64:67]
    ds_read_b64_tr_b16 v[56:57], v14 offset:36864
    ds_read_b64_tr_b16 v[58:59], v14 offset:37376
    v_mfma_f32_16x16x32_bf16 v[68:71], v[40:43], v[36:39], v[68:71]
    ds_read_b64_tr_b16 v[60:61], v15 offset:36864
    ds_read_b64_tr_b16 v[62:63], v15 offset:37376
    v_mfma_f32_16x16x32_bf16 v[72:75], v[44:47], v[32:35], v[72:75]
    ds_read_b128 v[48:51], v11 offset:32768
    ds_read_b128 v[52:55], v11 offset:34816
    v_mfma_f32_16x16x32_bf16 v[76:79], v[44:47], v[36:39], v[76:79]
    s_waitcnt lgkmcnt(0)
    s_barrier
    v_mfma_f32_16x16x32_bf16 v[64:67], v[56:59], v[48:51], v[64:67]
    ds_read_b64_tr_b16 v[40:41], v14 offset:49152
    ds_read_b64_tr_b16 v[42:43], v14 offset:49664
    v_mfma_f32_16x16x32_bf16 v[68:71], v[56:59], v[52:55], v[68:71]
    ds_read_b64_tr_b16 v[44:45], v15 offset:49152
    ds_read_b64_tr_b16 v[46:47], v15 offset:49664
    v_mfma_f32_16x16x32_bf16 v[72:75], v[60:63], v[48:51], v[72:75]
    ds_read_b128 v[32:35], v10 offset:49152
    ds_read_b128 v[36:39], v10 offset:51200
    v_mfma_f32_16x16x32_bf16 v[76:79], v[60:63], v[52:55], v[76:79]
    s_waitcnt lgkmcnt(0)
    v_mfma_f32_16x16x32_bf16 v[64:67], v[40:43], v[32:35], v[64:67]
    ds_read_b64_tr_b16 v[56:57], v14 offset:53248
    ds_read_b64_tr_b16 v[58:59], v14 offset:53760
    v_mfma_f32_16x16x32_bf16 v[68:71], v[40:43], v[36:39], v[68:71]
    ds_read_b64_tr_b16 v[60:61], v15 offset:53248
    ds_read_b64_tr_b16 v[62:63], v15 offset:53760
    v_mfma_f32_16x16x32_bf16 v[72:75], v[44:47], v[32:35], v[72:75]
    ds_read_b128 v[48:51], v11 offset:49152
    ds_read_b128 v[52:55], v11 offset:51200
    v_mfma_f32_16x16x32_bf16 v[76:79], v[44:47], v[36:39], v[76:79]
    s_waitcnt lgkmcnt(0)
    s_barrier
    v_mfma_f32_16x16x32_bf16 v[64:67], v[56:59], v[48:51], v[64:67]
    ds_read_b64_tr_b16 v[40:41], v16
    ds_read_b64_tr_b16 v[42:43], v16 offset:512
    v_mfma_f32_16x16x32_bf16 v[68:71], v[56:59], v[52:55], v[68:71]
    ds_read_b64_tr_b16 v[44:45], v17
    ds_read_b64_tr_b16 v[46:47], v17 offset:512
    v_mfma_f32_16x16x32_bf16 v[72:75], v[60:63], v[48:51], v[72:75]
    ds_read_b128 v[32:35], v12
    ds_read_b128 v[36:39], v12 offset:2048
    v_mfma_f32_16x16x32_bf16 v[76:79], v[60:63], v[52:55], v[76:79]
    s_waitcnt lgkmcnt(0)
    v_mfma_f32_16x16x32_bf16 v[64:67], v[40:43], v[32:35], v[64:67]
    ds_read_b64_tr_b16 v[56:57], v16 offset:4096
    ds_read_b64_tr_b16 v[58:59], v16 offset:4608
    v_mfma_f32_16x16x32_bf16 v[68:71], v[40:43], v[36:39], v[68:71]
    ds_read_b64_tr_b16 v[60:61], v17 offset:4096
    ds_read_b64_tr_b16 v[62:63], v17 offset:4608
    v_mfma_f32_16x16x32_bf16 v[72:75], v[44:47], v[32:35], v[72:75]
    ds_read_b128 v[48:51], v13
    ds_read_b128 v[52:55], v13 offset:2048
    v_mfma_f32_16x16x32_bf16 v[76:79], v[44:47], v[36:39], v[76:79]
    s_waitcnt lgkmcnt(0)
    s_barrier
    v_mfma_f32_16x16x32_bf16 v[64:67], v[56:59], v[48:51], v[64:67]
    ds_read_b64_tr_b16 v[40:41], v16 offset:16384
    ds_read_b64_tr_b16 v[42:43], v16 offset:16896
    v_mfma_f32_16x16x32_bf16 v[68:71], v[56:59], v[52:55], v[68:71]
    ds_read_b64_tr_b16 v[44:45], v17 offset:16384
    ds_read_b64_tr_b16 v[46:47], v17 offset:16896
    v_mfma_f32_16x16x32_bf16 v[72:75], v[60:63], v[48:51], v[72:75]
    ds_read_b128 v[32:35], v12 offset:16384
    ds_read_b128 v[36:39], v12 offset:18432
    v_mfma_f32_16x16x32_bf16 v[76:79], v[60:63], v[52:55], v[76:79]
    s_waitcnt lgkmcnt(0)
    v_mfma_f32_16x16x32_bf16 v[64:67], v[40:43], v[32:35], v[64:67]
    ds_read_b64_tr_b16 v[56:57], v16 offset:20480
    ds_read_b64_tr_b16 v[58:59], v16 offset:20992
    v_mfma_f32_16x16x32_bf16 v[68:71], v[40:43], v[36:39], v[68:71]
    ds_read_b64_tr_b16 v[60:61], v17 offset:20480
    ds_read_b64_tr_b16 v[62:63], v17 offset:20992
    v_mfma_f32_16x16x32_bf16 v[72:75], v[44:47], v[32:35], v[72:75]
    ds_read_b128 v[48:51], v13 offset:16384
    ds_read_b128 v[52:55], v13 offset:18432
    v_mfma_f32_16x16x32_bf16 v[76:79], v[44:47], v[36:39], v[76:79]
    s_waitcnt lgkmcnt(0)
    s_barrier
    v_mfma_f32_16x16x32_bf16 v[64:67], v[56:59], v[48:51], v[64:67]
    ds_read_b64_tr_b16 v[40:41], v16 offset:32768
    ds_read_b64_tr_b16 v[42:43], v16 offset:33280
    v_mfma_f32_16x16x32_bf16 v[68:71], v[56:59], v[52:55], v[68:71]
    ds_read_b64_tr_b16 v[44:45], v17 offset:32768
    ds_read_b64_tr_b16 v[46:47], v17 offset:33280
    v_mfma_f32_16x16x32_bf16 v[72:75], v[60:63], v[48:51], v[72:75]
    ds_read_b128 v[32:35], v12 offset:32768
    ds_read_b128 v[36:39], v12 offset:34816
    v_mfma_f32_16x16x32_bf16 v[76:79], v[60:63], v[52:55], v[76:79]
    s_waitcnt lgkmcnt(0)
    v_mfma_f32_16x16x32_bf16 v[64:67], v[40:43], v[32:35], v[64:67]
    ds_read_b64_tr_b16 v[56:57], v16 offset:36864
    ds_read_b64_tr_b16 v[58:59], v16 offset:37376
    v_mfma_f32_16x16x32_bf16 v[68:71], v[40:43], v[36:39], v[68:71]
    ds_read_b64_tr_b16 v[60:61], v17 offset:36864
    ds_read_b64_tr_b16 v[62:63], v17 offset:37376
    v_mfma_f32_16x16x32_bf16 v[72:75], v[44:47], v[32:35], v[72:75]
    ds_read_b128 v[48:51], v13 offset:32768
    ds_read_b128 v[52:55], v13 offset:34816
    v_mfma_f32_16x16x32_bf16 v[76:79], v[44:47], v[36:39], v[76:79]
    s_waitcnt lgkmcnt(0)
    s_barrier
    v_mfma_f32_16x16x32_bf16 v[64:67], v[56:59], v[48:51], v[64:67]
    ds_read_b64_tr_b16 v[40:41], v16 offset:49152
    ds_read_b64_tr_b16 v[42:43], v16 offset:49664
    v_mfma_f32_16x16x32_bf16 v[68:71], v[56:59], v[52:55], v[68:71]
    ds_read_b64_tr_b16 v[44:45], v17 offset:49152
    ds_read_b64_tr_b16 v[46:47], v17 offset:49664
    v_mfma_f32_16x16x32_bf16 v[72:75], v[60:63], v[48:51], v[72:75]
    ds_read_b128 v[32:35], v12 offset:49152
    ds_read_b128 v[36:39], v12 offset:51200
    v_mfma_f32_16x16x32_bf16 v[76:79], v[60:63], v[52:55], v[76:79]
    s_waitcnt lgkmcnt(0)
    v_mfma_f32_16x16x32_bf16 v[64:67], v[40:43], v[32:35], v[64:67]
    ds_read_b64_tr_b16 v[56:57], v16 offset:53248
    ds_read_b64_tr_b16 v[58:59], v16 offset:53760
    v_mfma_f32_16x16x32_bf16 v[68:71], v[40:43], v[36:39], v[68:71]
    ds_read_b64_tr_b16 v[60:61], v17 offset:53248
    ds_read_b64_tr_b16 v[62:63], v17 offset:53760
    v_mfma_f32_16x16x32_bf16 v[72:75], v[44:47], v[32:35], v[72:75]
    ds_read_b128 v[48:51], v13 offset:49152
    ds_read_b128 v[52:55], v13 offset:51200
    v_mfma_f32_16x16x32_bf16 v[76:79], v[44:47], v[36:39], v[76:79]
    s_waitcnt lgkmcnt(0)
    s_barrier
    v_mfma_f32_16x16x32_bf16 v[64:67], v[56:59], v[48:51], v[64:67]
    ds_read_b64_tr_b16 v[40:41], v14
    ds_read_b64_tr_b16 v[42:43], v14 offset:512
    v_mfma_f32_16x16x32_bf16 v[68:71], v[56:59], v[52:55], v[68:71]
    ds_read_b64_tr_b16 v[44:45], v15
    ds_read_b64_tr_b16 v[46:47], v15 offset:512
    v_mfma_f32_16x16x32_bf16 v[72:75], v[60:63], v[48:51], v[72:75]
    ds_read_b128 v[32:35], v10
    ds_read_b128 v[36:39], v10 offset:2048
    v_mfma_f32_16x16x32_bf16 v[76:79], v[60:63], v[52:55], v[76:79]
    s_waitcnt lgkmcnt(0)
    v_mfma_f32_16x16x32_bf16 v[64:67], v[40:43], v[32:35], v[64:67]
    ds_read_b64_tr_b16 v[56:57], v14 offset:4096
    ds_read_b64_tr_b16 v[58:59], v14 offset:4608
    v_mfma_f32_16x16x32_bf16 v[68:71], v[40:43], v[36:39], v[68:71]
    ds_read_b64_tr_b16 v[60:61], v15 offset:4096
    ds_read_b64_tr_b16 v[62:63], v15 offset:4608
    v_mfma_f32_16x16x32_bf16 v[72:75], v[44:47], v[32:35], v[72:75]
    ds_read_b128 v[48:51], v11
    ds_read_b128 v[52:55], v11 offset:2048
    v_mfma_f32_16x16x32_bf16 v[76:79], v[44:47], v[36:39], v[76:79]
    s_waitcnt lgkmcnt(0)
    s_barrier
    v_mfma_f32_16x16x32_bf16 v[64:67], v[56:59], v[48:51], v[64:67]
    ds_read_b64_tr_b16 v[40:41], v14 offset:16384
    ds_read_b64_tr_b16 v[42:43], v14 offset:16896
    v_mfma_f32_16x16x32_bf16 v[68:71], v[56:59], v[52:55], v[68:71]
    ds_read_b64_tr_b16 v[44:45], v15 offset:16384
    ds_read_b64_tr_b16 v[46:47], v15 offset:16896
    v_mfma_f32_16x16x32_bf16 v[72:75], v[60:63], v[48:51], v[72:75]
    ds_read_b128 v[32:35], v10 offset:16384
    ds_read_b128 v[36:39], v10 offset:18432
    v_mfma_f32_16x16x32_bf16 v[76:79], v[60:63], v[52:55], v[76:79]
    s_waitcnt lgkmcnt(0)
    v_mfma_f32_16x16x32_bf16 v[64:67], v[40:43], v[32:35], v[64:67]
    ds_read_b64_tr_b16 v[56:57], v14 offset:20480
    ds_read_b64_tr_b16 v[58:59], v14 offset:20992
    v_mfma_f32_16x16x32_bf16 v[68:71], v[40:43], v[36:39], v[68:71]
    ds_read_b64_tr_b16 v[60:61], v15 offset:20480
    ds_read_b64_tr_b16 v[62:63], v15 offset:20992
    v_mfma_f32_16x16x32_bf16 v[72:75], v[44:47], v[32:35], v[72:75]
    ds_read_b128 v[48:51], v11 offset:16384
    ds_read_b128 v[52:55], v11 offset:18432
    v_mfma_f32_16x16x32_bf16 v[76:79], v[44:47], v[36:39], v[76:79]
    s_waitcnt lgkmcnt(0)
    s_barrier
    v_mfma_f32_16x16x32_bf16 v[64:67], v[56:59], v[48:51], v[64:67]
    ds_read_b64_tr_b16 v[40:41], v14 offset:32768
    ds_read_b64_tr_b16 v[42:43], v14 offset:33280
    v_mfma_f32_16x16x32_bf16 v[68:71], v[56:59], v[52:55], v[68:71]
    ds_read_b64_tr_b16 v[44:45], v15 offset:32768
    ds_read_b64_tr_b16 v[46:47], v15 offset:33280
    v_mfma_f32_16x16x32_bf16 v[72:75], v[60:63], v[48:51], v[72:75]
    ds_read_b128 v[32:35], v10 offset:32768
    ds_read_b128 v[36:39], v10 offset:34816
    v_mfma_f32_16x16x32_bf16 v[76:79], v[60:63], v[52:55], v[76:79]
    s_waitcnt lgkmcnt(0)
    v_mfma_f32_16x16x32_bf16 v[64:67], v[40:43], v[32:35], v[64:67]
    ds_read_b64_tr_b16 v[56:57], v14 offset:36864
    ds_read_b64_tr_b16 v[58:59], v14 offset:37376
    v_mfma_f32_16x16x32_bf16 v[68:71], v[40:43], v[36:39], v[68:71]
    ds_read_b64_tr_b16 v[60:61], v15 offset:36864
    ds_read_b64_tr_b16 v[62:63], v15 offset:37376
    v_mfma_f32_16x16x32_bf16 v[72:75], v[44:47], v[32:35], v[72:75]
    ds_read_b128 v[48:51], v11 offset:32768
    ds_read_b128 v[52:55], v11 offset:34816
    v_mfma_f32_16x16x32_bf16 v[76:79], v[44:47], v[36:39], v[76:79]
    s_waitcnt lgkmcnt(0)
    s_barrier
    v_mfma_f32_16x16x32_bf16 v[64:67], v[56:59], v[48:51], v[64:67]
    ds_read_b64_tr_b16 v[40:41], v14 offset:49152
    ds_read_b64_tr_b16 v[42:43], v14 offset:49664
    v_mfma_f32_16x16x32_bf16 v[68:71], v[56:59], v[52:55], v[68:71]
    ds_read_b64_tr_b16 v[44:45], v15 offset:49152
    ds_read_b64_tr_b16 v[46:47], v15 offset:49664
    v_mfma_f32_16x16x32_bf16 v[72:75], v[60:63], v[48:51], v[72:75]
    ds_read_b128 v[32:35], v10 offset:49152
    ds_read_b128 v[36:39], v10 offset:51200
    v_mfma_f32_16x16x32_bf16 v[76:79], v[60:63], v[52:55], v[76:79]
    s_waitcnt lgkmcnt(0)
    v_mfma_f32_16x16x32_bf16 v[64:67], v[40:43], v[32:35], v[64:67]
    ds_read_b64_tr_b16 v[56:57], v14 offset:53248
    ds_read_b64_tr_b16 v[58:59], v14 offset:53760
    v_mfma_f32_16x16x32_bf16 v[68:71], v[40:43], v[36:39], v[68:71]
    ds_read_b64_tr_b16 v[60:61], v15 offset:53248
    ds_read_b64_tr_b16 v[62:63], v15 offset:53760
    v_mfma_f32_16x16x32_bf16 v[72:75], v[44:47], v[32:35], v[72:75]
    ds_read_b128 v[48:51], v11 offset:49152
    ds_read_b128 v[52:55], v11 offset:51200
    v_mfma_f32_16x16x32_bf16 v[76:79], v[44:47], v[36:39], v[76:79]
    s_waitcnt lgkmcnt(0)
    v_mfma_f32_16x16x32_bf16 v[64:67], v[56:59], v[48:51], v[64:67]
    v_mfma_f32_16x16x32_bf16 v[68:71], v[56:59], v[52:55], v[68:71]
    v_mfma_f32_16x16x32_bf16 v[72:75], v[60:63], v[48:51], v[72:75]
    v_mfma_f32_16x16x32_bf16 v[76:79], v[60:63], v[52:55], v[76:79]
    s_waitcnt vmcnt(0)
    v_lshlrev_b32 v86, 16, v28
    v_and_b32 v87, 4294901760, v28
    v_lshlrev_b32 v88, 16, v29
    v_and_b32 v89, 4294901760, v29
    v_cvt_pk_bf16_f32 v84, v64, v65
    v_lshlrev_b32 v64, 16, v84
    v_and_b32 v65, 4294901760, v84
    v_cvt_pk_bf16_f32 v85, v66, v67
    v_lshlrev_b32 v66, 16, v85
    v_and_b32 v67, 4294901760, v85
    v_pk_add_f32 v[64:65], v[64:65], v[86:87]
    v_pk_add_f32 v[66:67], v[66:67], v[88:89]
    v_cvt_pk_bf16_f32 v84, v64, v65
    v_lshlrev_b32 v64, 16, v84
    v_and_b32 v65, 4294901760, v84
    v_cvt_pk_bf16_f32 v85, v66, v67
    v_lshlrev_b32 v66, 16, v85
    v_and_b32 v67, 4294901760, v85
    v_lshlrev_b32 v80, 16, v20
    v_and_b32 v81, 4294901760, v20
    v_lshlrev_b32 v82, 16, v21
    v_and_b32 v83, 4294901760, v21
    v_pk_add_f32 v[64:65], v[64:65], v[80:81]
    v_pk_add_f32 v[66:67], v[66:67], v[82:83]
    v_cvt_pk_bf16_f32 v20, v64, v65
    v_cvt_pk_bf16_f32 v21, v66, v67
    buffer_store_dwordx2 v[20:21], v8, s[52:55], 0 offen
    v_cvt_pk_bf16_f32 v84, v68, v69
    v_lshlrev_b32 v68, 16, v84
    v_and_b32 v69, 4294901760, v84
    v_cvt_pk_bf16_f32 v85, v70, v71
    v_lshlrev_b32 v70, 16, v85
    v_and_b32 v71, 4294901760, v85
    v_pk_add_f32 v[68:69], v[68:69], v[86:87]
    v_pk_add_f32 v[70:71], v[70:71], v[88:89]
    v_cvt_pk_bf16_f32 v84, v68, v69
    v_lshlrev_b32 v68, 16, v84
    v_and_b32 v69, 4294901760, v84
    v_cvt_pk_bf16_f32 v85, v70, v71
    v_lshlrev_b32 v70, 16, v85
    v_and_b32 v71, 4294901760, v85
    v_lshlrev_b32 v80, 16, v22
    v_and_b32 v81, 4294901760, v22
    v_lshlrev_b32 v82, 16, v23
    v_and_b32 v83, 4294901760, v23
    v_pk_add_f32 v[68:69], v[68:69], v[80:81]
    v_pk_add_f32 v[70:71], v[70:71], v[82:83]
    v_cvt_pk_bf16_f32 v22, v68, v69
    v_cvt_pk_bf16_f32 v23, v70, v71
    buffer_store_dwordx2 v[22:23], v8, s[52:55], s62 offen
    v_lshlrev_b32 v90, 16, v30
    v_and_b32 v91, 4294901760, v30
    v_lshlrev_b32 v92, 16, v31
    v_and_b32 v93, 4294901760, v31
    v_cvt_pk_bf16_f32 v84, v72, v73
    v_lshlrev_b32 v72, 16, v84
    v_and_b32 v73, 4294901760, v84
    v_cvt_pk_bf16_f32 v85, v74, v75
    v_lshlrev_b32 v74, 16, v85
    v_and_b32 v75, 4294901760, v85
    v_pk_add_f32 v[72:73], v[72:73], v[90:91]
    v_pk_add_f32 v[74:75], v[74:75], v[92:93]
    v_cvt_pk_bf16_f32 v84, v72, v73
    v_lshlrev_b32 v72, 16, v84
    v_and_b32 v73, 4294901760, v84
    v_cvt_pk_bf16_f32 v85, v74, v75
    v_lshlrev_b32 v74, 16, v85
    v_and_b32 v75, 4294901760, v85
    v_lshlrev_b32 v80, 16, v24
    v_and_b32 v81, 4294901760, v24
    v_lshlrev_b32 v82, 16, v25
    v_and_b32 v83, 4294901760, v25
    v_pk_add_f32 v[72:73], v[72:73], v[80:81]
    v_pk_add_f32 v[74:75], v[74:75], v[82:83]
    v_cvt_pk_bf16_f32 v24, v72, v73
    v_cvt_pk_bf16_f32 v25, v74, v75
    buffer_store_dwordx2 v[24:25], v8, s[52:55], 0 offen offset:32
    v_cvt_pk_bf16_f32 v84, v76, v77
    v_lshlrev_b32 v76, 16, v84
    v_and_b32 v77, 4294901760, v84
    v_cvt_pk_bf16_f32 v85, v78, v79
    v_lshlrev_b32 v78, 16, v85
    v_and_b32 v79, 4294901760, v85
    v_pk_add_f32 v[76:77], v[76:77], v[90:91]
    v_pk_add_f32 v[78:79], v[78:79], v[92:93]
    v_cvt_pk_bf16_f32 v84, v76, v77
    v_lshlrev_b32 v76, 16, v84
    v_and_b32 v77, 4294901760, v84
    v_cvt_pk_bf16_f32 v85, v78, v79
    v_lshlrev_b32 v78, 16, v85
    v_and_b32 v79, 4294901760, v85
    v_lshlrev_b32 v80, 16, v26
    v_and_b32 v81, 4294901760, v26
    v_lshlrev_b32 v82, 16, v27
    v_and_b32 v83, 4294901760, v27
    v_pk_add_f32 v[76:77], v[76:77], v[80:81]
    v_pk_add_f32 v[78:79], v[78:79], v[82:83]
    v_cvt_pk_bf16_f32 v26, v76, v77
    v_cvt_pk_bf16_f32 v27, v78, v79
    buffer_store_dwordx2 v[26:27], v8, s[52:55], s62 offen offset:32
    s_endpgm
L_sequential_preLN__sliding_local_dilated__mixer_channel_mlp__prompt_k4_kernel_loader:
    s_sub_u32 s58, s3, 4
    v_lshrrev_b32 v3, 3, v1
    v_and_b32 v4, 7, v1
    v_xor_b32 v5, v4, v3
    v_lshlrev_b32 v5, 4, v5
    s_lshl_b32 s63, s56, 6
    s_lshl_b32 s64, s58, 4
    s_add_u32 s63, s63, s64
    v_add_u32 v6, s63, v3
    s_mov_b32 s66, 3584
    v_mul_lo_u32 v6, v6, s66
    v_add_u32 v7, v6, v5
    s_lshl_b32 s65, s58, 11
    v_and_b32 v6, 2, v3
    v_xor_b32 v6, v6, v4
    v_lshlrev_b32 v6, 4, v6
    s_lshl_b32 s63, s58, 4
    s_add_u32 s63, s63, 0
    v_add_u32 v8, s63, v3
    v_lshl_add_u32 v8, v8, 10, v6
    s_lshl_b32 s63, s57, 7
    v_add_u32 v8, s63, v8
    v_and_b32 v6, 2, v3
    v_or_b32 v6, 4, v6
    v_xor_b32 v6, v6, v4
    v_lshlrev_b32 v6, 4, v6
    s_lshl_b32 s63, s58, 4
    s_add_u32 s63, s63, 8
    v_add_u32 v9, s63, v3
    v_lshl_add_u32 v9, v9, 10, v6
    s_lshl_b32 s63, s57, 7
    v_add_u32 v9, s63, v9
    s_waitcnt lgkmcnt(0)
    s_add_u32 s36, s34, 4194304
    s_addc_u32 s37, s35, 0
    s_and_b32 s37, s37, 65535
    s_mov_b32 s38, 7340032
    s_mov_b32 s39, 131072
    s_mov_b32 s40, s28
    s_and_b32 s41, s29, 65535
    s_mov_b32 s42, 1835008
    s_mov_b32 s43, 131072
    s_add_u32 s44, s34, 2097152
    s_addc_u32 s45, s35, 0
    s_and_b32 s45, s45, 65535
    s_mov_b32 s46, 2097152
    s_mov_b32 s47, 131072
    s_mov_b32 s48, s30
    s_and_b32 s49, s31, 65535
    s_mov_b32 s50, 1024
    s_mov_b32 s51, 131072
    s_mov_b32 s52, s32
    s_and_b32 s53, s33, 65535
    s_mov_b32 s54, 2097152
    s_mov_b32 s55, 131072
    s_and_b32 s68, s2, 7
    s_mul_i32 s68, s68, 28
    s_lshr_b32 s68, s68, 3
    s_add_u32 m0, s65, 8192
    s_lshl_b32 s67, s68, 16
    buffer_load_dwordx4 v8, s[40:43], s67 offen lds
    s_add_u32 m0, s65, 9216
    s_lshl_b32 s67, s68, 16
    buffer_load_dwordx4 v9, s[40:43], s67 offen lds
    s_add_u32 m0, s65, 0
    s_lshl_b32 s67, s68, 7
    buffer_load_dwordx4 v7, s[36:39], s67 offen lds
    s_add_u32 m0, s65, 1024
    s_lshl_b32 s67, s68, 7
    s_add_u32 s67, s67, 28672
    buffer_load_dwordx4 v7, s[36:39], s67 offen lds
    s_add_u32 s68, s68, 1
    s_cmp_ge_u32 s68, 28
    s_cselect_b32 s68, 0, s68
    s_add_u32 m0, s65, 24576
    s_lshl_b32 s67, s68, 16
    buffer_load_dwordx4 v8, s[40:43], s67 offen lds
    s_add_u32 m0, s65, 25600
    s_lshl_b32 s67, s68, 16
    buffer_load_dwordx4 v9, s[40:43], s67 offen lds
    s_add_u32 m0, s65, 16384
    s_lshl_b32 s67, s68, 7
    buffer_load_dwordx4 v7, s[36:39], s67 offen lds
    s_add_u32 m0, s65, 17408
    s_lshl_b32 s67, s68, 7
    s_add_u32 s67, s67, 28672
    buffer_load_dwordx4 v7, s[36:39], s67 offen lds
    s_add_u32 s68, s68, 1
    s_cmp_ge_u32 s68, 28
    s_cselect_b32 s68, 0, s68
    s_waitcnt vmcnt(4)
    s_barrier
    s_add_u32 m0, s65, 40960
    s_lshl_b32 s67, s68, 16
    buffer_load_dwordx4 v8, s[40:43], s67 offen lds
    s_add_u32 m0, s65, 41984
    s_lshl_b32 s67, s68, 16
    buffer_load_dwordx4 v9, s[40:43], s67 offen lds
    s_add_u32 m0, s65, 32768
    s_lshl_b32 s67, s68, 7
    buffer_load_dwordx4 v7, s[36:39], s67 offen lds
    s_add_u32 m0, s65, 33792
    s_lshl_b32 s67, s68, 7
    s_add_u32 s67, s67, 28672
    buffer_load_dwordx4 v7, s[36:39], s67 offen lds
    s_add_u32 s68, s68, 1
    s_cmp_ge_u32 s68, 28
    s_cselect_b32 s68, 0, s68
    s_add_u32 m0, s65, 57344
    s_lshl_b32 s67, s68, 16
    buffer_load_dwordx4 v8, s[40:43], s67 offen lds
    s_add_u32 m0, s65, 58368
    s_lshl_b32 s67, s68, 16
    buffer_load_dwordx4 v9, s[40:43], s67 offen lds
    s_add_u32 m0, s65, 49152
    s_lshl_b32 s67, s68, 7
    buffer_load_dwordx4 v7, s[36:39], s67 offen lds
    s_add_u32 m0, s65, 50176
    s_lshl_b32 s67, s68, 7
    s_add_u32 s67, s67, 28672
    buffer_load_dwordx4 v7, s[36:39], s67 offen lds
    s_add_u32 s68, s68, 1
    s_cmp_ge_u32 s68, 28
    s_cselect_b32 s68, 0, s68
    s_waitcnt vmcnt(8)
    s_barrier
    s_add_u32 m0, s65, 73728
    s_lshl_b32 s67, s68, 16
    buffer_load_dwordx4 v8, s[40:43], s67 offen lds
    s_add_u32 m0, s65, 74752
    s_lshl_b32 s67, s68, 16
    buffer_load_dwordx4 v9, s[40:43], s67 offen lds
    s_add_u32 m0, s65, 65536
    s_lshl_b32 s67, s68, 7
    buffer_load_dwordx4 v7, s[36:39], s67 offen lds
    s_add_u32 m0, s65, 66560
    s_lshl_b32 s67, s68, 7
    s_add_u32 s67, s67, 28672
    buffer_load_dwordx4 v7, s[36:39], s67 offen lds
    s_add_u32 s68, s68, 1
    s_cmp_ge_u32 s68, 28
    s_cselect_b32 s68, 0, s68
    s_add_u32 m0, s65, 90112
    s_lshl_b32 s67, s68, 16
    buffer_load_dwordx4 v8, s[40:43], s67 offen lds
    s_add_u32 m0, s65, 91136
    s_lshl_b32 s67, s68, 16
    buffer_load_dwordx4 v9, s[40:43], s67 offen lds
    s_add_u32 m0, s65, 81920
    s_lshl_b32 s67, s68, 7
    buffer_load_dwordx4 v7, s[36:39], s67 offen lds
    s_add_u32 m0, s65, 82944
    s_lshl_b32 s67, s68, 7
    s_add_u32 s67, s67, 28672
    buffer_load_dwordx4 v7, s[36:39], s67 offen lds
    s_add_u32 s68, s68, 1
    s_cmp_ge_u32 s68, 28
    s_cselect_b32 s68, 0, s68
    s_waitcnt vmcnt(12)
    s_barrier
    s_add_u32 m0, s65, 106496
    s_lshl_b32 s67, s68, 16
    buffer_load_dwordx4 v8, s[40:43], s67 offen lds
    s_add_u32 m0, s65, 107520
    s_lshl_b32 s67, s68, 16
    buffer_load_dwordx4 v9, s[40:43], s67 offen lds
    s_add_u32 m0, s65, 98304
    s_lshl_b32 s67, s68, 7
    buffer_load_dwordx4 v7, s[36:39], s67 offen lds
    s_add_u32 m0, s65, 99328
    s_lshl_b32 s67, s68, 7
    s_add_u32 s67, s67, 28672
    buffer_load_dwordx4 v7, s[36:39], s67 offen lds
    s_add_u32 s68, s68, 1
    s_cmp_ge_u32 s68, 28
    s_cselect_b32 s68, 0, s68
    s_add_u32 m0, s65, 122880
    s_lshl_b32 s67, s68, 16
    buffer_load_dwordx4 v8, s[40:43], s67 offen lds
    s_add_u32 m0, s65, 123904
    s_lshl_b32 s67, s68, 16
    buffer_load_dwordx4 v9, s[40:43], s67 offen lds
    s_add_u32 m0, s65, 114688
    s_lshl_b32 s67, s68, 7
    buffer_load_dwordx4 v7, s[36:39], s67 offen lds
    s_add_u32 m0, s65, 115712
    s_lshl_b32 s67, s68, 7
    s_add_u32 s67, s67, 28672
    buffer_load_dwordx4 v7, s[36:39], s67 offen lds
    s_add_u32 s68, s68, 1
    s_cmp_ge_u32 s68, 28
    s_cselect_b32 s68, 0, s68
    s_waitcnt vmcnt(16)
    s_barrier
    s_add_u32 m0, s65, 8192
    s_lshl_b32 s67, s68, 16
    buffer_load_dwordx4 v8, s[40:43], s67 offen lds
    s_add_u32 m0, s65, 9216
    s_lshl_b32 s67, s68, 16
    buffer_load_dwordx4 v9, s[40:43], s67 offen lds
    s_add_u32 m0, s65, 0
    s_lshl_b32 s67, s68, 7
    buffer_load_dwordx4 v7, s[36:39], s67 offen lds
    s_add_u32 m0, s65, 1024
    s_lshl_b32 s67, s68, 7
    s_add_u32 s67, s67, 28672
    buffer_load_dwordx4 v7, s[36:39], s67 offen lds
    s_add_u32 s68, s68, 1
    s_cmp_ge_u32 s68, 28
    s_cselect_b32 s68, 0, s68
    s_add_u32 m0, s65, 24576
    s_lshl_b32 s67, s68, 16
    buffer_load_dwordx4 v8, s[40:43], s67 offen lds
    s_add_u32 m0, s65, 25600
    s_lshl_b32 s67, s68, 16
    buffer_load_dwordx4 v9, s[40:43], s67 offen lds
    s_add_u32 m0, s65, 16384
    s_lshl_b32 s67, s68, 7
    buffer_load_dwordx4 v7, s[36:39], s67 offen lds
    s_add_u32 m0, s65, 17408
    s_lshl_b32 s67, s68, 7
    s_add_u32 s67, s67, 28672
    buffer_load_dwordx4 v7, s[36:39], s67 offen lds
    s_add_u32 s68, s68, 1
    s_cmp_ge_u32 s68, 28
    s_cselect_b32 s68, 0, s68
    s_waitcnt vmcnt(20)
    s_barrier
    s_add_u32 m0, s65, 40960
    s_lshl_b32 s67, s68, 16
    buffer_load_dwordx4 v8, s[40:43], s67 offen lds
    s_add_u32 m0, s65, 41984
    s_lshl_b32 s67, s68, 16
    buffer_load_dwordx4 v9, s[40:43], s67 offen lds
    s_add_u32 m0, s65, 32768
    s_lshl_b32 s67, s68, 7
    buffer_load_dwordx4 v7, s[36:39], s67 offen lds
    s_add_u32 m0, s65, 33792
    s_lshl_b32 s67, s68, 7
    s_add_u32 s67, s67, 28672
    buffer_load_dwordx4 v7, s[36:39], s67 offen lds
    s_add_u32 s68, s68, 1
    s_cmp_ge_u32 s68, 28
    s_cselect_b32 s68, 0, s68
    s_add_u32 m0, s65, 57344
    s_lshl_b32 s67, s68, 16
    buffer_load_dwordx4 v8, s[40:43], s67 offen lds
    s_add_u32 m0, s65, 58368
    s_lshl_b32 s67, s68, 16
    buffer_load_dwordx4 v9, s[40:43], s67 offen lds
    s_add_u32 m0, s65, 49152
    s_lshl_b32 s67, s68, 7
    buffer_load_dwordx4 v7, s[36:39], s67 offen lds
    s_add_u32 m0, s65, 50176
    s_lshl_b32 s67, s68, 7
    s_add_u32 s67, s67, 28672
    buffer_load_dwordx4 v7, s[36:39], s67 offen lds
    s_add_u32 s68, s68, 1
    s_cmp_ge_u32 s68, 28
    s_cselect_b32 s68, 0, s68
    s_waitcnt vmcnt(24)
    s_barrier
    s_add_u32 m0, s65, 73728
    s_lshl_b32 s67, s68, 16
    buffer_load_dwordx4 v8, s[40:43], s67 offen lds
    s_add_u32 m0, s65, 74752
    s_lshl_b32 s67, s68, 16
    buffer_load_dwordx4 v9, s[40:43], s67 offen lds
    s_add_u32 m0, s65, 65536
    s_lshl_b32 s67, s68, 7
    buffer_load_dwordx4 v7, s[36:39], s67 offen lds
    s_add_u32 m0, s65, 66560
    s_lshl_b32 s67, s68, 7
    s_add_u32 s67, s67, 28672
    buffer_load_dwordx4 v7, s[36:39], s67 offen lds
    s_add_u32 s68, s68, 1
    s_cmp_ge_u32 s68, 28
    s_cselect_b32 s68, 0, s68
    s_waitcnt vmcnt(24)
    s_barrier
    s_add_u32 m0, s65, 90112
    s_lshl_b32 s67, s68, 16
    buffer_load_dwordx4 v8, s[40:43], s67 offen lds
    s_add_u32 m0, s65, 91136
    s_lshl_b32 s67, s68, 16
    buffer_load_dwordx4 v9, s[40:43], s67 offen lds
    s_add_u32 m0, s65, 81920
    s_lshl_b32 s67, s68, 7
    buffer_load_dwordx4 v7, s[36:39], s67 offen lds
    s_add_u32 m0, s65, 82944
    s_lshl_b32 s67, s68, 7
    s_add_u32 s67, s67, 28672
    buffer_load_dwordx4 v7, s[36:39], s67 offen lds
    s_add_u32 s68, s68, 1
    s_cmp_ge_u32 s68, 28
    s_cselect_b32 s68, 0, s68
    s_waitcnt vmcnt(24)
    s_barrier
    s_add_u32 m0, s65, 106496
    s_lshl_b32 s67, s68, 16
    buffer_load_dwordx4 v8, s[40:43], s67 offen lds
    s_add_u32 m0, s65, 107520
    s_lshl_b32 s67, s68, 16
    buffer_load_dwordx4 v9, s[40:43], s67 offen lds
    s_add_u32 m0, s65, 98304
    s_lshl_b32 s67, s68, 7
    buffer_load_dwordx4 v7, s[36:39], s67 offen lds
    s_add_u32 m0, s65, 99328
    s_lshl_b32 s67, s68, 7
    s_add_u32 s67, s67, 28672
    buffer_load_dwordx4 v7, s[36:39], s67 offen lds
    s_add_u32 s68, s68, 1
    s_cmp_ge_u32 s68, 28
    s_cselect_b32 s68, 0, s68
    s_waitcnt vmcnt(24)
    s_barrier
    s_add_u32 m0, s65, 122880
    s_lshl_b32 s67, s68, 16
    buffer_load_dwordx4 v8, s[40:43], s67 offen lds
    s_add_u32 m0, s65, 123904
    s_lshl_b32 s67, s68, 16
    buffer_load_dwordx4 v9, s[40:43], s67 offen lds
    s_add_u32 m0, s65, 114688
    s_lshl_b32 s67, s68, 7
    buffer_load_dwordx4 v7, s[36:39], s67 offen lds
    s_add_u32 m0, s65, 115712
    s_lshl_b32 s67, s68, 7
    s_add_u32 s67, s67, 28672
    buffer_load_dwordx4 v7, s[36:39], s67 offen lds
    s_add_u32 s68, s68, 1
    s_cmp_ge_u32 s68, 28
    s_cselect_b32 s68, 0, s68
    s_waitcnt vmcnt(24)
    s_barrier
    s_add_u32 m0, s65, 8192
    s_lshl_b32 s67, s68, 16
    buffer_load_dwordx4 v8, s[40:43], s67 offen lds
    s_add_u32 m0, s65, 9216
    s_lshl_b32 s67, s68, 16
    buffer_load_dwordx4 v9, s[40:43], s67 offen lds
    s_add_u32 m0, s65, 0
    s_lshl_b32 s67, s68, 7
    buffer_load_dwordx4 v7, s[36:39], s67 offen lds
    s_add_u32 m0, s65, 1024
    s_lshl_b32 s67, s68, 7
    s_add_u32 s67, s67, 28672
    buffer_load_dwordx4 v7, s[36:39], s67 offen lds
    s_add_u32 s68, s68, 1
    s_cmp_ge_u32 s68, 28
    s_cselect_b32 s68, 0, s68
    s_waitcnt vmcnt(24)
    s_barrier
    s_add_u32 m0, s65, 24576
    s_lshl_b32 s67, s68, 16
    buffer_load_dwordx4 v8, s[40:43], s67 offen lds
    s_add_u32 m0, s65, 25600
    s_lshl_b32 s67, s68, 16
    buffer_load_dwordx4 v9, s[40:43], s67 offen lds
    s_add_u32 m0, s65, 16384
    s_lshl_b32 s67, s68, 7
    buffer_load_dwordx4 v7, s[36:39], s67 offen lds
    s_add_u32 m0, s65, 17408
    s_lshl_b32 s67, s68, 7
    s_add_u32 s67, s67, 28672
    buffer_load_dwordx4 v7, s[36:39], s67 offen lds
    s_add_u32 s68, s68, 1
    s_cmp_ge_u32 s68, 28
    s_cselect_b32 s68, 0, s68
    s_waitcnt vmcnt(24)
    s_barrier
    s_add_u32 m0, s65, 40960
    s_lshl_b32 s67, s68, 16
    buffer_load_dwordx4 v8, s[40:43], s67 offen lds
    s_add_u32 m0, s65, 41984
    s_lshl_b32 s67, s68, 16
    buffer_load_dwordx4 v9, s[40:43], s67 offen lds
    s_add_u32 m0, s65, 32768
    s_lshl_b32 s67, s68, 7
    buffer_load_dwordx4 v7, s[36:39], s67 offen lds
    s_add_u32 m0, s65, 33792
    s_lshl_b32 s67, s68, 7
    s_add_u32 s67, s67, 28672
    buffer_load_dwordx4 v7, s[36:39], s67 offen lds
    s_add_u32 s68, s68, 1
    s_cmp_ge_u32 s68, 28
    s_cselect_b32 s68, 0, s68
    s_waitcnt vmcnt(24)
    s_barrier
    s_add_u32 m0, s65, 57344
    s_lshl_b32 s67, s68, 16
    buffer_load_dwordx4 v8, s[40:43], s67 offen lds
    s_add_u32 m0, s65, 58368
    s_lshl_b32 s67, s68, 16
    buffer_load_dwordx4 v9, s[40:43], s67 offen lds
    s_add_u32 m0, s65, 49152
    s_lshl_b32 s67, s68, 7
    buffer_load_dwordx4 v7, s[36:39], s67 offen lds
    s_add_u32 m0, s65, 50176
    s_lshl_b32 s67, s68, 7
    s_add_u32 s67, s67, 28672
    buffer_load_dwordx4 v7, s[36:39], s67 offen lds
    s_add_u32 s68, s68, 1
    s_cmp_ge_u32 s68, 28
    s_cselect_b32 s68, 0, s68
    s_waitcnt vmcnt(24)
    s_barrier
    s_add_u32 m0, s65, 73728
    s_lshl_b32 s67, s68, 16
    buffer_load_dwordx4 v8, s[40:43], s67 offen lds
    s_add_u32 m0, s65, 74752
    s_lshl_b32 s67, s68, 16
    buffer_load_dwordx4 v9, s[40:43], s67 offen lds
    s_add_u32 m0, s65, 65536
    s_lshl_b32 s67, s68, 7
    buffer_load_dwordx4 v7, s[36:39], s67 offen lds
    s_add_u32 m0, s65, 66560
    s_lshl_b32 s67, s68, 7
    s_add_u32 s67, s67, 28672
    buffer_load_dwordx4 v7, s[36:39], s67 offen lds
    s_add_u32 s68, s68, 1
    s_cmp_ge_u32 s68, 28
    s_cselect_b32 s68, 0, s68
    s_waitcnt vmcnt(24)
    s_barrier
    s_add_u32 m0, s65, 90112
    s_lshl_b32 s67, s68, 16
    buffer_load_dwordx4 v8, s[40:43], s67 offen lds
    s_add_u32 m0, s65, 91136
    s_lshl_b32 s67, s68, 16
    buffer_load_dwordx4 v9, s[40:43], s67 offen lds
    s_add_u32 m0, s65, 81920
    s_lshl_b32 s67, s68, 7
    buffer_load_dwordx4 v7, s[36:39], s67 offen lds
    s_add_u32 m0, s65, 82944
    s_lshl_b32 s67, s68, 7
    s_add_u32 s67, s67, 28672
    buffer_load_dwordx4 v7, s[36:39], s67 offen lds
    s_add_u32 s68, s68, 1
    s_cmp_ge_u32 s68, 28
    s_cselect_b32 s68, 0, s68
    s_waitcnt vmcnt(24)
    s_barrier
    s_add_u32 m0, s65, 106496
    s_lshl_b32 s67, s68, 16
    buffer_load_dwordx4 v8, s[40:43], s67 offen lds
    s_add_u32 m0, s65, 107520
    s_lshl_b32 s67, s68, 16
    buffer_load_dwordx4 v9, s[40:43], s67 offen lds
    s_add_u32 m0, s65, 98304
    s_lshl_b32 s67, s68, 7
    buffer_load_dwordx4 v7, s[36:39], s67 offen lds
    s_add_u32 m0, s65, 99328
    s_lshl_b32 s67, s68, 7
    s_add_u32 s67, s67, 28672
    buffer_load_dwordx4 v7, s[36:39], s67 offen lds
    s_add_u32 s68, s68, 1
    s_cmp_ge_u32 s68, 28
    s_cselect_b32 s68, 0, s68
    s_waitcnt vmcnt(24)
    s_barrier
    s_add_u32 m0, s65, 122880
    s_lshl_b32 s67, s68, 16
    buffer_load_dwordx4 v8, s[40:43], s67 offen lds
    s_add_u32 m0, s65, 123904
    s_lshl_b32 s67, s68, 16
    buffer_load_dwordx4 v9, s[40:43], s67 offen lds
    s_add_u32 m0, s65, 114688
    s_lshl_b32 s67, s68, 7
    buffer_load_dwordx4 v7, s[36:39], s67 offen lds
    s_add_u32 m0, s65, 115712
    s_lshl_b32 s67, s68, 7
    s_add_u32 s67, s67, 28672
    buffer_load_dwordx4 v7, s[36:39], s67 offen lds
    s_add_u32 s68, s68, 1
    s_cmp_ge_u32 s68, 28
    s_cselect_b32 s68, 0, s68
    s_waitcnt vmcnt(24)
    s_barrier
    s_add_u32 m0, s65, 8192
    s_lshl_b32 s67, s68, 16
    buffer_load_dwordx4 v8, s[40:43], s67 offen lds
    s_add_u32 m0, s65, 9216
    s_lshl_b32 s67, s68, 16
    buffer_load_dwordx4 v9, s[40:43], s67 offen lds
    s_add_u32 m0, s65, 0
    s_lshl_b32 s67, s68, 7
    buffer_load_dwordx4 v7, s[36:39], s67 offen lds
    s_add_u32 m0, s65, 1024
    s_lshl_b32 s67, s68, 7
    s_add_u32 s67, s67, 28672
    buffer_load_dwordx4 v7, s[36:39], s67 offen lds
    s_add_u32 s68, s68, 1
    s_cmp_ge_u32 s68, 28
    s_cselect_b32 s68, 0, s68
    s_waitcnt vmcnt(24)
    s_barrier
    s_add_u32 m0, s65, 24576
    s_lshl_b32 s67, s68, 16
    buffer_load_dwordx4 v8, s[40:43], s67 offen lds
    s_add_u32 m0, s65, 25600
    s_lshl_b32 s67, s68, 16
    buffer_load_dwordx4 v9, s[40:43], s67 offen lds
    s_add_u32 m0, s65, 16384
    s_lshl_b32 s67, s68, 7
    buffer_load_dwordx4 v7, s[36:39], s67 offen lds
    s_add_u32 m0, s65, 17408
    s_lshl_b32 s67, s68, 7
    s_add_u32 s67, s67, 28672
    buffer_load_dwordx4 v7, s[36:39], s67 offen lds
    s_add_u32 s68, s68, 1
    s_cmp_ge_u32 s68, 28
    s_cselect_b32 s68, 0, s68
    s_waitcnt vmcnt(24)
    s_barrier
    s_add_u32 m0, s65, 40960
    s_lshl_b32 s67, s68, 16
    buffer_load_dwordx4 v8, s[40:43], s67 offen lds
    s_add_u32 m0, s65, 41984
    s_lshl_b32 s67, s68, 16
    buffer_load_dwordx4 v9, s[40:43], s67 offen lds
    s_add_u32 m0, s65, 32768
    s_lshl_b32 s67, s68, 7
    buffer_load_dwordx4 v7, s[36:39], s67 offen lds
    s_add_u32 m0, s65, 33792
    s_lshl_b32 s67, s68, 7
    s_add_u32 s67, s67, 28672
    buffer_load_dwordx4 v7, s[36:39], s67 offen lds
    s_add_u32 s68, s68, 1
    s_cmp_ge_u32 s68, 28
    s_cselect_b32 s68, 0, s68
    s_waitcnt vmcnt(24)
    s_barrier
    s_add_u32 m0, s65, 57344
    s_lshl_b32 s67, s68, 16
    buffer_load_dwordx4 v8, s[40:43], s67 offen lds
    s_add_u32 m0, s65, 58368
    s_lshl_b32 s67, s68, 16
    buffer_load_dwordx4 v9, s[40:43], s67 offen lds
    s_add_u32 m0, s65, 49152
    s_lshl_b32 s67, s68, 7
    buffer_load_dwordx4 v7, s[36:39], s67 offen lds
    s_add_u32 m0, s65, 50176
    s_lshl_b32 s67, s68, 7
    s_add_u32 s67, s67, 28672
    buffer_load_dwordx4 v7, s[36:39], s67 offen lds
    s_add_u32 s68, s68, 1
    s_cmp_ge_u32 s68, 28
    s_cselect_b32 s68, 0, s68
    s_waitcnt vmcnt(24)
    s_barrier
    s_waitcnt vmcnt(20)
    s_barrier
    s_waitcnt vmcnt(16)
    s_barrier
    s_waitcnt vmcnt(12)
    s_barrier
    s_waitcnt vmcnt(8)
    s_barrier
    s_waitcnt vmcnt(4)
    s_barrier
    s_waitcnt vmcnt(0)
    s_barrier
L_sequential_preLN__sliding_local_dilated__mixer_channel_mlp__prompt_k4_kernel_end:
    s_endpgm
.section .rodata,"a"
.p2align 6
.amdhsa_kernel sequential_preLN__sliding_local_dilated__mixer_channel_mlp__prompt_k4_kernel
  .amdhsa_next_free_vgpr 94
  .amdhsa_next_free_sgpr 69
  .amdhsa_accum_offset 96
  .amdhsa_group_segment_fixed_size 0
  .amdhsa_kernarg_size 88
  .amdhsa_user_sgpr_count 2
  .amdhsa_user_sgpr_kernarg_segment_ptr 1
  .amdhsa_system_sgpr_workgroup_id_x 1
.end_amdhsa_kernel
.text
```
